```python
import torch

def _softmax(x, axis=-1):
    return torch.softmax(x, dim=axis)
def _gelu(x):
    return torch.nn.functional.gelu(x, approximate="tanh")
def _silu(x):
    return torch.nn.functional.silu(x)
def _sigmoid(x):
    return torch.sigmoid(x)
def _layernorm(x, axis=-1, eps=1e-5):
    m = x.mean(dim=axis, keepdim=True)
    v = x.var(dim=axis, keepdim=True, unbiased=False)
    return (x - m) / torch.sqrt(v + eps)
def _scatter_add(tgt, idx, src, axis=0):
    return tgt.clone().index_add_(axis, idx, src)
def _segment_sum(src, seg, n):
    out = torch.zeros((n,) + src.shape[1:], dtype=src.dtype)
    return out.index_add_(0, seg, src)
def _pad(x, pw):
    flat = tuple(v for pair in reversed(pw) for v in pair)
    return torch.nn.functional.pad(x, flat)

kernel_name = 'sequential_preLN__ssm_conv_h3__glu_gated_glu__prompt'

def setup_inputs():

    _w = (lambda a: (lambda t: t.to(torch.bfloat16) if t.is_floating_point() else t)(torch.as_tensor(a)))
    def _A_setup():
        B, S, D = 1, 2048, 448
        ks = 4
        return {
            "q": _w((lambda *s: torch.randn(*s, dtype=torch.bfloat16) * 0.05)(B, S, D)),
            "k": _w((lambda *s: torch.randn(*s, dtype=torch.bfloat16) * 0.4)(B, S, D)),
            "v": _w((lambda *s: torch.randn(*s, dtype=torch.bfloat16) * 0.4)(B, S, D)),
            "shift_k": _w((lambda *s: torch.randn(*s, dtype=torch.bfloat16) * 0.4)(D, ks) * 0.5),
            "ssm_k": _w((lambda *s: torch.randn(*s, dtype=torch.bfloat16) * 0.4)(D, S) * (1.0 / S ** 0.5)),
            "ssm_D": _w((lambda *s: torch.randn(*s, dtype=torch.bfloat16) * 0.4)(D)),
        }
    _A_in = _A_setup()

    def _B_setup():
        B, S, D, F = 1, 2048, 448, 1792
        return {
            "x": _w((lambda *s: torch.randn(*s, dtype=torch.bfloat16) * 0.05)(B, S, D)),
            "w_gate": _w((lambda *s: torch.randn(*s, dtype=torch.bfloat16) * 0.05)(D, F)),
            "w_up": _w((lambda *s: torch.randn(*s, dtype=torch.bfloat16) * 0.05)(D, F)),
            "w_down": _w((lambda *s: torch.randn(*s, dtype=torch.bfloat16) * 0.05)(F, D)),
        }
    _B_in = _B_setup()

    return {
        "A_q": _A_in["q"],
        "A_k": _A_in["k"],
        "A_v": _A_in["v"],
        "A_shift_k": _A_in["shift_k"],
        "A_ssm_k": _A_in["ssm_k"],
        "A_ssm_D": _A_in["ssm_D"],
        "B_x": _B_in["x"],
        "B_w_gate": _B_in["w_gate"],
        "B_w_up": _B_in["w_up"],
        "B_w_down": _B_in["w_down"],
    }

def reference(A_q, A_k, A_v, A_shift_k, A_ssm_k, A_ssm_D, B_x, B_w_gate, B_w_up, B_w_down):
    def _A_ref(q, k, v, shift_k, ssm_k, ssm_D):
        B, S, D = q.shape
        ks = shift_k.shape[-1]
        k_pad = _pad(k, ((0, 0), (ks - 1, 0), (0, 0)))
        k_shift = torch.zeros_like(k)
        for t in range(ks):
            k_shift = k_shift + k_pad[:, t:t + S, :] * shift_k[:, ks - 1 - t][None, None, :]
        kv = k_shift * v
        L = 2 * S
        kv_pad = _pad(kv, ((0, 0), (0, S), (0, 0)))
        kf_pad = _pad(ssm_k, ((0, 0), (0, S)))
        kv_f = (lambda x, axes=(-2,-1): torch.fft.rfft2(x.float(), dim=axes))(kv_pad[:, None, :, :], axes=(1, 2))
        kf_f = (lambda x, axes=(-2,-1): torch.fft.rfft2(x.float(), dim=axes))(kf_pad[:, None, :], axes=(1, 2))
        kf_f = (lambda x, *d: x.permute(*d))(kf_f, 1, 2, 0)
        y_f = kv_f * kf_f[None, :, :, :]
        y = (lambda x, s, axes=(-2,-1): torch.fft.irfft2(x, s=s, dim=axes).to(torch.bfloat16))(y_f, (1, L), axes=(1, 2))[:, 0, :S, :]
        y = y + kv * ssm_D[None, None, :]
        return q * y

    def _B_ref(x, w_gate, w_up, w_down):
        g = torch.einsum("bsd,df->bsf", x, w_gate)
        u = torch.einsum("bsd,df->bsf", x, w_up)
        h = _sigmoid(g) * u
        return torch.einsum("bsf,fd->bsd", h, w_down)

    x = A_q
    h = x + _A_ref(_layernorm(x, axis=-1), A_k, A_v, A_shift_k, A_ssm_k, A_ssm_D)
    h2 = h + _B_ref(_layernorm(h, axis=-1), B_w_gate, B_w_up, B_w_down)
    return h2
```

```asm
; @launch grid=(256,1,1) block=(256,1,1) lds=163840
.amdgcn_target "amdgcn-amd-amdhsa--gfx950"
.text
.globl sequential_preLN__ssm_conv_h3__glu_gated_glu__prompt_kernel
.p2align 8
.type sequential_preLN__ssm_conv_h3__glu_gated_glu__prompt_kernel,@function
sequential_preLN__ssm_conv_h3__glu_gated_glu__prompt_kernel:
    s_cmp_ge_u32 s2, 256
    s_cbranch_scc1 L_end
    s_load_dwordx16 s[4:19], s[0:1], 0
    s_load_dwordx8 s[20:27], s[0:1], 64
    s_load_dwordx2 s[28:29], s[0:1], 96
    s_getpc_b64 s[94:95]
L_pc:
    v_lshlrev_b32 v4, 7, v0
    v_min_u32 v4, L_end-L_pc, v4
    v_mov_b32 v5, s95
    v_add_co_u32 v4, vcc, s94, v4
    s_nop 1
    v_addc_co_u32 v5, vcc, 0, v5, vcc
    global_load_dword v1, v[4:5], off
    s_waitcnt lgkmcnt(0)
    s_mov_b32 s36, s6
    s_and_b32 s37, s7, 0xffff
    s_mov_b32 s38, 0x1c0000
    s_mov_b32 s39, 0x20000
    s_mov_b32 s40, s8
    s_and_b32 s41, s9, 0xffff
    s_mov_b32 s42, 0x1c0000
    s_mov_b32 s43, 0x20000
    s_mov_b32 s32, s4
    s_and_b32 s33, s5, 0xffff
    s_mov_b32 s34, 0x1c0000
    s_mov_b32 s35, 0x20000
    s_mov_b32 s4, s10
    s_and_b32 s5, s11, 0xffff
    s_mov_b32 s6, 0xe00
    s_mov_b32 s7, 0x20000
    s_mov_b32 s60, s24
    s_and_b32 s61, s25, 0xffff
    s_mov_b32 s62, 0x1c0000
    s_mov_b32 s63, 0x20000
    s_cmp_ge_u32 s2, 224
    s_cbranch_scc1 L_helper
L_main:
    s_and_b32 s72, s2, 31
    s_lshr_b32 s73, s2, 5
    v_and_b32 v15, 15, v0
    v_bfe_u32 v19, v0, 6, 1
    v_lshl_add_u32 v15, v19, 4, v15
    v_bfe_u32 v16, v0, 4, 2
    v_lshrrev_b32 v19, 7, v0
    v_lshl_add_u32 v16, v19, 2, v16
    s_mul_i32 s74, s72, 57344
    s_lshl_b32 s75, s73, 7
    s_add_u32 s74, s74, s75
    v_mul_u32_u24 v17, 7168, v16
    v_lshl_add_u32 v17, v15, 2, v17
    v_add_u32 v17, s74, v17
    v_subrev_u32 v18, 2688, v17
    s_movk_i32 s76, 4480
    buffer_load_dword v25, v17, s[36:39], 0 offen offset:0
    buffer_load_dword v26, v17, s[36:39], 0 offen offset:896
    buffer_load_dword v27, v17, s[36:39], 0 offen offset:1792
    buffer_load_dword v28, v17, s[36:39], 0 offen offset:2688
    buffer_load_dword v29, v17, s[36:39], 0 offen offset:3584
    buffer_load_dword v30, v17, s[36:39], s76 offen offset:0
    buffer_load_dword v31, v17, s[36:39], s76 offen offset:896
    buffer_load_dword v32, v17, s[36:39], s76 offen offset:1792
    buffer_load_dword v22, v18, s[36:39], 0 offen offset:0
    buffer_load_dword v23, v18, s[36:39], 0 offen offset:896
    buffer_load_dword v24, v18, s[36:39], 0 offen offset:1792
    s_lshl_b32 s74, s73, 9
    v_lshl_add_u32 v19, v15, 4, s74
    buffer_load_dwordx4 v[52:55], v19, s[4:7], 0 offen
    buffer_load_dword v34, v17, s[40:43], 0 offen offset:0
    buffer_load_dword v35, v17, s[40:43], 0 offen offset:896
    buffer_load_dword v36, v17, s[40:43], 0 offen offset:1792
    buffer_load_dword v37, v17, s[40:43], 0 offen offset:2688
    buffer_load_dword v38, v17, s[40:43], 0 offen offset:3584
    buffer_load_dword v39, v17, s[40:43], s76 offen offset:0
    buffer_load_dword v40, v17, s[40:43], s76 offen offset:896
    buffer_load_dword v41, v17, s[40:43], s76 offen offset:1792
    buffer_load_dword v42, v17, s[32:35], 0 offen offset:0
    buffer_load_dword v43, v17, s[32:35], 0 offen offset:896
    buffer_load_dword v44, v17, s[32:35], 0 offen offset:1792
    buffer_load_dword v45, v17, s[32:35], 0 offen offset:2688
    buffer_load_dword v46, v17, s[32:35], 0 offen offset:3584
    buffer_load_dword v47, v17, s[32:35], s76 offen offset:0
    buffer_load_dword v48, v17, s[32:35], s76 offen offset:896
    buffer_load_dword v49, v17, s[32:35], s76 offen offset:1792
    s_lshl_b32 s72, s2, 13
    s_add_u32 s64, s12, s72
    s_addc_u32 s65, s13, 0
    s_and_b32 s65, s65, 0xffff
    s_mov_b32 s66, 4096
    s_mov_b32 s67, 0x20000
    s_lshl_b32 s72, s2, 13
    s_add_u32 s72, s72, 4096
    s_add_u32 s68, s12, s72
    s_addc_u32 s69, s13, 0
    s_and_b32 s69, s69, 0xffff
    s_mov_b32 s70, 4096
    s_mov_b32 s71, 0x20000
    v_lshlrev_b32 v57, 4, v0
    v_subrev_u32 v56, 16, v57
    buffer_load_dwordx4 v[60:63], v56, s[64:67], 0 offen
    buffer_load_dwordx4 v[64:67], v57, s[64:67], 0 offen
    buffer_load_dwordx4 v[68:71], v56, s[68:71], 0 offen
    buffer_load_dwordx4 v[72:75], v57, s[68:71], 0 offen
    s_mov_b32 s44, s28
    s_and_b32 s45, s29, 0xffff
    s_mov_b32 s46, 0xe20000
    s_mov_b32 s47, 0x20000
    s_mov_b32 s8, s14
    s_and_b32 s9, s15, 0xffff
    s_mov_b32 s10, 0x380
    s_mov_b32 s11, 0x20000
    s_mov_b32 s48, s18
    s_and_b32 s49, s19, 0xffff
    s_mov_b32 s50, 0x188000
    s_mov_b32 s51, 0x20000
    s_mov_b32 s52, s20
    s_and_b32 s53, s21, 0xffff
    s_mov_b32 s54, 0x188000
    s_mov_b32 s55, 0x20000
    s_mov_b32 s56, s22
    s_and_b32 s57, s23, 0xffff
    s_mov_b32 s58, 0x188000
    s_mov_b32 s59, 0x20000
    v_mov_b32 v4, 0
    buffer_load_dword v8, v4, s[44:47], 0 offen sc1
    s_lshr_b32 s72, s2, 3
    s_lshl_b32 s72, s72, 7
    s_and_b32 s73, s2, 7
    s_lshl_b32 s74, s73, 2
    s_add_u32 s72, s72, s74
    v_lshlrev_b32 v9, 12, v0
    v_add_u32 v9, s72, v9
    v_mov_b32 v11, 0x80000000
    v_cmp_gt_u32 vcc, 8, v0
    s_nop 1
    v_cndmask_b32 v9, v11, v9, vcc
    v_and_b32 v11, 63, v0
    v_min_u32 v11, 55, v11
    v_lshrrev_b32 v10, 1, v11
    v_lshlrev_b32 v10, 7, v10
    v_and_b32 v11, 1, v11
    v_lshl_add_u32 v10, v11, 4, v10
    s_lshl_b32 s73, s73, 12
    v_add_u32 v10, s73, v10
    v_and_b32 v4, 63, v0
    v_lshrrev_b32 v14, 1, v4
    v_lshlrev_b32 v14, 7, v14
    v_and_b32 v4, 1, v4
    v_lshl_add_u32 v14, v4, 4, v14
    s_and_b32 s73, s2, 7
    s_lshl_b32 s73, s73, 12
    v_add_u32 v14, s73, v14
    v_and_b32 v4, 15, v0
    v_lshrrev_b32 v10, 1, v4
    s_lshr_b32 s72, s2, 5
    s_lshl_b32 s72, s72, 2
    s_sub_u32 s72, s72, 24
    v_mov_b32 v5, s72
    v_cmp_gt_u32 vcc, 4, v10
    s_nop 1
    v_cndmask_b32 v5, 0, v5, vcc
    v_add_u32 v10, v10, v5
    v_add_u32 v10, 24, v10
    v_lshlrev_b32 v10, 7, v10
    v_and_b32 v4, 1, v4
    v_lshl_add_u32 v10, v4, 4, v10
    s_and_b32 s73, s2, 7
    s_lshl_b32 s73, s73, 12
    v_add_u32 v10, s73, v10
    s_and_b32 s72, s2, 7
    s_lshr_b32 s73, s2, 3
    s_mul_i32 s74, s73, 37
    s_lshr_b32 s74, s74, 8
    s_mul_i32 s75, s74, 7
    s_sub_u32 s75, s73, s75
    s_lshr_b32 s86, s72, 1
    s_lshl_b32 s86, s86, 2
    s_add_u32 s86, s86, s74
    s_and_b32 s87, s72, 1
    s_mul_i32 s87, s87, 7
    s_add_u32 s87, s87, s75
    v_readfirstlane_b32 s88, v0
    s_nop 0
    s_lshr_b32 s88, s88, 6
    s_and_b32 s72, s2, 7
    s_lshr_b32 s73, s2, 3
    s_mul_i32 s74, s73, 37
    s_lshr_b32 s74, s74, 8
    s_mul_i32 s75, s74, 7
    s_sub_u32 s91, s73, s75
    s_lshl_b32 s90, s72, 2
    s_add_u32 s90, s90, s74
    v_readfirstlane_b32 s88, v0
    s_nop 0
    s_lshr_b32 s88, s88, 6
    s_lshl_b32 s72, s86, 7
    s_lshl_b32 s73, s87, 2
    s_add_u32 s72, s72, s73
    v_mov_b32 v4, 0x80000000
    v_mov_b32 v12, s72
    v_cmp_eq_u32 vcc, 0, v0
    s_nop 1
    v_cndmask_b32 v12, v4, v12, vcc
    s_lshr_b32 s72, s90, 1
    s_lshl_b32 s72, s72, 7
    v_and_b32 v4, 63, v0
    v_min_u32 v4, 13, v4
    v_lshlrev_b32 v4, 2, v4
    v_add_u32 v13, s72, v4
    s_and_b32 s72, s2, 31
    s_lshr_b32 s73, s2, 5
    s_lshl_b32 s74, s73, 18
    s_lshl_b32 s75, s72, 7
    s_add_u32 s74, s74, s75
    v_lshlrev_b32 v76, 13, v15
    v_lshl_add_u32 v76, v16, 4, v76
    v_add_u32 v76, s74, v76
    s_mov_b32 s77, 0x100000
    s_mov_b32 s78, 0x101000
    s_mov_b32 s79, 0x300000
    s_mov_b32 s80, 0x301000
    s_mov_b32 s81, 0xffff0000
    s_mov_b32 s82, 0x05040100
    s_mov_b32 s83, 0x07060302
    s_waitcnt vmcnt(32)
    v_lshlrev_b32 v92, 16, v25
    v_and_b32 v93, s81, v25
    s_waitcnt vmcnt(31)
    v_lshlrev_b32 v94, 16, v26
    v_and_b32 v95, s81, v26
    s_waitcnt vmcnt(30)
    v_lshlrev_b32 v96, 16, v27
    v_and_b32 v97, s81, v27
    s_waitcnt vmcnt(29)
    v_lshlrev_b32 v98, 16, v28
    v_and_b32 v99, s81, v28
    s_waitcnt vmcnt(28)
    v_lshlrev_b32 v100, 16, v29
    v_and_b32 v101, s81, v29
    s_waitcnt vmcnt(27)
    v_lshlrev_b32 v102, 16, v30
    v_and_b32 v103, s81, v30
    s_waitcnt vmcnt(26)
    v_lshlrev_b32 v104, 16, v31
    v_and_b32 v105, s81, v31
    s_waitcnt vmcnt(25)
    v_lshlrev_b32 v106, 16, v32
    v_and_b32 v107, s81, v32
    s_waitcnt vmcnt(24)
    v_lshlrev_b32 v86, 16, v22
    v_and_b32 v87, s81, v22
    s_waitcnt vmcnt(23)
    v_lshlrev_b32 v88, 16, v23
    v_and_b32 v89, s81, v23
    s_waitcnt vmcnt(22)
    v_lshlrev_b32 v90, 16, v24
    v_and_b32 v91, s81, v24
    s_waitcnt vmcnt(21)
    v_lshlrev_b32 v78, 16, v52
    v_lshlrev_b32 v79, 16, v54
    v_and_b32 v80, s81, v52
    v_and_b32 v81, s81, v54
    v_lshlrev_b32 v82, 16, v53
    v_lshlrev_b32 v83, 16, v55
    v_and_b32 v84, s81, v53
    v_and_b32 v85, s81, v55
    v_pk_mul_f32 v[108:109], v[92:93], v[78:79]
    v_pk_mul_f32 v[110:111], v[94:95], v[78:79]
    v_pk_mul_f32 v[112:113], v[96:97], v[78:79]
    v_pk_mul_f32 v[114:115], v[98:99], v[78:79]
    v_pk_mul_f32 v[116:117], v[100:101], v[78:79]
    v_pk_mul_f32 v[118:119], v[102:103], v[78:79]
    v_pk_mul_f32 v[120:121], v[104:105], v[78:79]
    v_pk_mul_f32 v[122:123], v[106:107], v[78:79]
    v_pk_fma_f32 v[108:109], v[90:91], v[80:81], v[108:109]
    v_pk_fma_f32 v[110:111], v[92:93], v[80:81], v[110:111]
    v_pk_fma_f32 v[112:113], v[94:95], v[80:81], v[112:113]
    v_pk_fma_f32 v[114:115], v[96:97], v[80:81], v[114:115]
    v_pk_fma_f32 v[116:117], v[98:99], v[80:81], v[116:117]
    v_pk_fma_f32 v[118:119], v[100:101], v[80:81], v[118:119]
    v_pk_fma_f32 v[120:121], v[102:103], v[80:81], v[120:121]
    v_pk_fma_f32 v[122:123], v[104:105], v[80:81], v[122:123]
    v_pk_fma_f32 v[108:109], v[88:89], v[82:83], v[108:109]
    v_pk_fma_f32 v[110:111], v[90:91], v[82:83], v[110:111]
    v_pk_fma_f32 v[112:113], v[92:93], v[82:83], v[112:113]
    v_pk_fma_f32 v[114:115], v[94:95], v[82:83], v[114:115]
    v_pk_fma_f32 v[116:117], v[96:97], v[82:83], v[116:117]
    v_pk_fma_f32 v[118:119], v[98:99], v[82:83], v[118:119]
    v_pk_fma_f32 v[120:121], v[100:101], v[82:83], v[120:121]
    v_pk_fma_f32 v[122:123], v[102:103], v[82:83], v[122:123]
    v_pk_fma_f32 v[108:109], v[86:87], v[84:85], v[108:109]
    v_pk_fma_f32 v[110:111], v[88:89], v[84:85], v[110:111]
    v_pk_fma_f32 v[112:113], v[90:91], v[84:85], v[112:113]
    v_pk_fma_f32 v[114:115], v[92:93], v[84:85], v[114:115]
    v_pk_fma_f32 v[116:117], v[94:95], v[84:85], v[116:117]
    v_pk_fma_f32 v[118:119], v[96:97], v[84:85], v[118:119]
    v_pk_fma_f32 v[120:121], v[98:99], v[84:85], v[120:121]
    v_pk_fma_f32 v[122:123], v[100:101], v[84:85], v[122:123]
    s_waitcnt vmcnt(20)
    v_lshlrev_b32 v86, 16, v34
    v_and_b32 v87, s81, v34
    s_waitcnt vmcnt(19)
    v_lshlrev_b32 v88, 16, v35
    v_and_b32 v89, s81, v35
    s_waitcnt vmcnt(18)
    v_lshlrev_b32 v90, 16, v36
    v_and_b32 v91, s81, v36
    s_waitcnt vmcnt(17)
    v_lshlrev_b32 v92, 16, v37
    v_and_b32 v93, s81, v37
    s_waitcnt vmcnt(16)
    v_lshlrev_b32 v94, 16, v38
    v_and_b32 v95, s81, v38
    s_waitcnt vmcnt(15)
    v_lshlrev_b32 v96, 16, v39
    v_and_b32 v97, s81, v39
    s_waitcnt vmcnt(14)
    v_lshlrev_b32 v98, 16, v40
    v_and_b32 v99, s81, v40
    s_waitcnt vmcnt(13)
    v_lshlrev_b32 v100, 16, v41
    v_and_b32 v101, s81, v41
    v_pk_mul_f32 v[108:109], v[108:109], v[86:87]
    v_pk_mul_f32 v[110:111], v[110:111], v[88:89]
    v_pk_mul_f32 v[112:113], v[112:113], v[90:91]
    v_pk_mul_f32 v[114:115], v[114:115], v[92:93]
    v_pk_mul_f32 v[116:117], v[116:117], v[94:95]
    v_pk_mul_f32 v[118:119], v[118:119], v[96:97]
    v_pk_mul_f32 v[120:121], v[120:121], v[98:99]
    v_pk_mul_f32 v[122:123], v[122:123], v[100:101]
    v_cvt_pk_bf16_f32 v124, v122, v120
    v_cvt_pk_bf16_f32 v125, v118, v116
    v_cvt_pk_bf16_f32 v126, v114, v112
    v_cvt_pk_bf16_f32 v127, v110, v108
    v_cvt_pk_bf16_f32 v128, v123, v121
    v_cvt_pk_bf16_f32 v129, v119, v117
    v_cvt_pk_bf16_f32 v130, v115, v113
    v_cvt_pk_bf16_f32 v131, v111, v109
    buffer_store_dwordx4 v[124:127], v76, s[44:47], s77 offen sc1
    buffer_store_dwordx4 v[128:131], v76, s[44:47], s78 offen sc1
    s_waitcnt vmcnt(13)
    v_perm_b32 v132, v43, v42, s82
    s_waitcnt vmcnt(11)
    v_perm_b32 v133, v45, v44, s82
    s_waitcnt vmcnt(9)
    v_perm_b32 v134, v47, v46, s82
    s_waitcnt vmcnt(7)
    v_perm_b32 v135, v49, v48, s82
    v_perm_b32 v136, v43, v42, s83
    v_perm_b32 v137, v45, v44, s83
    v_perm_b32 v138, v47, v46, s83
    v_perm_b32 v139, v49, v48, s83
    buffer_store_dwordx4 v[132:135], v76, s[44:47], s79 offen sc1
    buffer_store_dwordx4 v[136:139], v76, s[44:47], s80 offen sc1
    s_waitcnt vmcnt(4)
    v_readfirstlane_b32 s93, v8
    s_nop 0
    s_add_u32 s93, s93, 0x9e3779b9
    s_barrier
    s_and_b32 s72, s86, 3
    s_mul_i32 s72, s72, 401408
    s_lshl_b32 s73, s87, 8
    s_add_u32 s72, s72, s73
    v_lshrrev_b32 v140, 1, v0
    v_mul_u32_u24 v140, 3584, v140
    v_and_b32 v141, 1, v0
    v_lshl_add_u32 v140, v141, 7, v140
    v_add_u32 v140, s72, v140
    v_mov_b32 v141, 0x80000000
    v_cmp_gt_u32 vcc, 224, v0
    s_nop 1
    v_cndmask_b32 v140, v141, v140, vcc
    buffer_load_dword v142, v140, s[48:51], 0 offen
    buffer_load_dword v143, v140, s[52:55], 0 offen
    v_mov_b32 v144, 0
    v_mov_b32 v145, 0
    v_mov_b32 v146, 0
    v_mov_b32 v147, 0
    v_and_b32 v148, 31, v0
    v_lshrrev_b32 v148, 2, v148
    v_mul_u32_u24 v148, 262, v148
    v_and_b32 v149, 3, v0
    v_add_u32 v148, v148, v149
    v_bfe_u32 v149, v0, 5, 1
    v_mul_u32_u24 v149, 2096, v149
    v_add_lshl_u32 v148, v148, v149, 4
    ds_write_b128 v148, v[144:147] offset:0
    v_bfe_u32 v148, v0, 2, 5
    v_mul_u32_u24 v148, 80, v148
    v_and_b32 v149, 3, v0
    v_lshl_add_u32 v148, v149, 4, v148
    v_lshrrev_b32 v149, 7, v0
    v_mul_u32_u24 v149, 7680, v149
    v_add_u32 v148, v148, v149
    v_add_u32 v148, 67072, v148
    ds_write_b128 v148, v[144:147]
    ds_write_b128 v57, v[64:67] offset:64
    ds_write_b128 v57, v[62:65] offset:16832
    v_mov_b32 v150, v61
    v_mov_b32 v151, v62
    v_mov_b32 v152, v63
    v_mov_b32 v153, v64
    v_mov_b32 v154, v65
    v_mov_b32 v155, v66
    ds_write_b128 v57, v[150:153] offset:8448
    ds_write_b128 v57, v[152:155] offset:25216
    v_alignbit_b32 v156, v61, v60, 16
    v_alignbit_b32 v157, v62, v61, 16
    v_alignbit_b32 v158, v63, v62, 16
    v_alignbit_b32 v159, v64, v63, 16
    v_alignbit_b32 v160, v65, v64, 16
    v_alignbit_b32 v161, v66, v65, 16
    ds_write_b128 v57, v[156:159] offset:4256
    ds_write_b128 v57, v[158:161] offset:21024
    v_alignbit_b32 v162, v62, v61, 16
    v_alignbit_b32 v163, v63, v62, 16
    v_alignbit_b32 v164, v64, v63, 16
    v_alignbit_b32 v165, v65, v64, 16
    v_alignbit_b32 v166, v66, v65, 16
    v_alignbit_b32 v167, v67, v66, 16
    ds_write_b128 v57, v[162:165] offset:12640
    ds_write_b128 v57, v[164:167] offset:29408
    ds_write_b128 v57, v[72:75] offset:33600
    ds_write_b128 v57, v[70:73] offset:50368
    v_mov_b32 v150, v69
    v_mov_b32 v151, v70
    v_mov_b32 v152, v71
    v_mov_b32 v153, v72
    v_mov_b32 v154, v73
    v_mov_b32 v155, v74
    ds_write_b128 v57, v[150:153] offset:41984
    ds_write_b128 v57, v[152:155] offset:58752
    v_alignbit_b32 v156, v69, v68, 16
    v_alignbit_b32 v157, v70, v69, 16
    v_alignbit_b32 v158, v71, v70, 16
    v_alignbit_b32 v159, v72, v71, 16
    v_alignbit_b32 v160, v73, v72, 16
    v_alignbit_b32 v161, v74, v73, 16
    ds_write_b128 v57, v[156:159] offset:37792
    ds_write_b128 v57, v[158:161] offset:54560
    v_alignbit_b32 v162, v70, v69, 16
    v_alignbit_b32 v163, v71, v70, 16
    v_alignbit_b32 v164, v72, v71, 16
    v_alignbit_b32 v165, v73, v72, 16
    v_alignbit_b32 v166, v74, v73, 16
    v_alignbit_b32 v167, v75, v74, 16
    ds_write_b128 v57, v[162:165] offset:46176
    ds_write_b128 v57, v[164:167] offset:62944
    s_waitcnt vmcnt(2)
    s_barrier
    s_mov_b32 s100, 0x1000
    v_mov_b32 v4, s93
    buffer_store_dword v4, v9, s[44:47], s100 offen sc1
    v_and_b32 v21, 63, v0
    v_lshrrev_b32 v22, 2, v21
    v_mul_u32_u24 v15, 3584, v22
    v_and_b32 v22, 3, v21
    v_lshl_add_u32 v15, v22, 4, v15
    v_xor_b32 v16, 32, v15
    v_bfe_u32 v22, v21, 4, 1
    v_mul_u32_u24 v23, 2080, v22
    v_lshrrev_b32 v22, 5, v21
    v_lshl_add_u32 v23, v22, 9, v23
    v_bfe_u32 v22, v21, 2, 2
    v_lshl_add_u32 v23, v22, 6, v23
    v_and_b32 v22, 3, v21
    v_lshl_add_u32 v23, v22, 3, v23
    s_mul_i32 s72, s88, 12288
    s_add_u32 s72, s72, 98816
    v_add_u32 v17, s72, v23
    v_xor_b32 v18, 32, v17
    s_mul_i32 s72, s88, 16384
    s_add_u32 s72, s72, 0
    v_add_u32 v19, s72, v23
    v_xor_b32 v20, 32, v19
    s_lshl_b32 s95, s87, 8
    s_lshl_b32 s72, s88, 6
    s_add_u32 s95, s95, s72
    s_mul_i32 s94, s88, 12288
    s_add_u32 s94, s94, 98816
    s_mul_i32 s81, s88, 16384
    s_add_u32 s81, s81, 0
    s_add_u32 m0, s94, 0
    s_add_u32 s72, s95, 0
    buffer_load_dwordx4 v15, s[48:51], s72 offen lds
    s_add_u32 m0, s94, 1024
    s_add_u32 s72, s95, 57344
    buffer_load_dwordx4 v15, s[48:51], s72 offen lds
    s_add_u32 m0, s94, 2048
    s_add_u32 s72, s95, 0
    buffer_load_dwordx4 v16, s[52:55], s72 offen lds
    s_add_u32 m0, s94, 3072
    s_add_u32 s72, s95, 57344
    buffer_load_dwordx4 v16, s[52:55], s72 offen lds
    s_add_u32 m0, s94, 4096
    s_add_u32 s72, s95, 114688
    buffer_load_dwordx4 v15, s[48:51], s72 offen lds
    s_add_u32 m0, s94, 5120
    s_add_u32 s72, s95, 172032
    buffer_load_dwordx4 v15, s[48:51], s72 offen lds
    s_add_u32 m0, s94, 6144
    s_add_u32 s72, s95, 114688
    buffer_load_dwordx4 v16, s[52:55], s72 offen lds
    s_add_u32 m0, s94, 7168
    s_add_u32 s72, s95, 172032
    buffer_load_dwordx4 v16, s[52:55], s72 offen lds
    s_add_u32 m0, s94, 8192
    s_add_u32 s72, s95, 229376
    buffer_load_dwordx4 v15, s[48:51], s72 offen lds
    s_add_u32 m0, s94, 9216
    s_add_u32 s72, s95, 286720
    buffer_load_dwordx4 v15, s[48:51], s72 offen lds
    s_add_u32 m0, s94, 10240
    s_add_u32 s72, s95, 229376
    buffer_load_dwordx4 v16, s[52:55], s72 offen lds
    s_add_u32 m0, s94, 11264
    s_add_u32 s72, s95, 286720
    buffer_load_dwordx4 v16, s[52:55], s72 offen lds
    v_readfirstlane_b32 s72, v0
    s_nop 0
    s_lshr_b32 s84, s72, 7
    s_bfe_u32 s85, s72, 0x10006
    v_and_b32 v33, 63, v0
    v_and_b32 v37, 31, v0
    v_bfe_u32 v38, v0, 5, 1
    v_lshrrev_b32 v34, 2, v37
    v_lshlrev_b32 v34, 2, v34
    s_mov_b32 s72, 0x71352460
    v_lshrrev_b32_e64 v36, v34, s72
    v_and_b32 v36, 7, v36
    v_and_b32 v34, 3, v37
    v_lshl_add_u32 v36, v36, 2, v34
    v_add_u32 v36, 1, v36
    v_and_b32 v34, 7, v36
    v_lshrrev_b32 v35, 3, v36
    v_mul_u32_u24 v21, 262, v34
    v_min_u32 v34, 1, v34
    v_add3_u32 v21, v21, v34, v35
    v_sub_u32 v21, v21, v38
    s_mul_i32 s72, s84, 2096
    s_lshl_b32 s73, s85, 1
    s_sub_u32 s72, s72, s73
    s_add_u32 s72, s72, 3
    v_add_u32 v21, s72, v21
    v_lshlrev_b32 v21, 4, v21
    s_mul_i32 s72, s84, 7680
    s_lshl_b32 s73, s85, 5
    s_add_u32 s72, s72, s73
    s_add_u32 s72, s72, 67152
    v_mul_u32_u24 v22, 80, v37
    v_lshl_add_u32 v22, v38, 4, v22
    v_add_u32 v22, s72, v22
    s_lshl_b32 s72, s85, 5
    v_add_u32 v34, s72, v37
    v_mov_b32 v37, v34
    v_mul_u32_u24 v36, 3, v38
    v_sub_u32 v35, 2, v38
    s_mul_i32 s72, s84, 7680
    s_add_u32 s72, s72, 69632
    v_mul_u32_u24 v34, 80, v37
    v_add_u32 v34, s72, v34
    v_lshl_add_u32 v25, v36, 4, v34
    v_lshl_add_u32 v26, v35, 4, v34
    s_lshl_b32 s72, s2, 13
    s_lshl_b32 s73, s84, 12
    s_add_u32 s72, s72, s73
    v_lshlrev_b32 v34, 6, v37
    v_add_u32 v34, s72, v34
    v_lshl_add_u32 v23, v36, 4, v34
    v_lshl_add_u32 v24, v35, 4, v34
    s_lshl_b32 s73, s85, 13
    s_add_u32 s73, s73, 0x40000
    v_lshlrev_b32 v34, 4, v33
    v_add_u32 v27, s73, v34
    v_add_u32 v28, 4096, v27
    s_lshl_b32 s73, s85, 11
    s_add_u32 s72, s72, s73
    s_add_u32 s72, s72, 0x500000
    v_and_b32 v34, 15, v33
    v_lshlrev_b32 v29, 6, v34
    v_lshrrev_b32 v34, 4, v33
    v_lshlrev_b32 v34, 2, v34
    s_movk_i32 s73, 0x1320
    v_lshrrev_b32_e64 v34, v34, s73
    v_and_b32 v34, 3, v34
    v_lshl_add_u32 v29, v34, 4, v29
    v_add_u32 v29, s72, v29
    v_lshrrev_b32 v34, 6, v0
    v_lshlrev_b32 v30, 12, v34
    v_lshl_add_u32 v30, v33, 4, v30
    v_add_u32 v30, 82432, v30
    v_xor_b32 v31, 4096, v30
    s_lshl_b32 s72, s2, 2
    s_lshl_b32 s73, s84, 1
    s_add_u32 s72, s72, s73
    v_mov_b32 v32, s72
    s_cmp_lg_u32 s88, 0
    s_cbranch_scc1 L_A_done
    s_mov_b32 s100, 0x1000
    s_mov_b32 s101, 0
L_A_loop:
    buffer_load_dwordx4 v[4:7], v10, s[44:47], s100 offen sc1
    s_waitcnt vmcnt(0)
    v_xor_b32 v4, s93, v4
    v_xor_b32 v5, s93, v5
    v_xor_b32 v6, s93, v6
    v_xor_b32 v7, s93, v7
    v_or3_b32 v4, v4, v5, v6
    v_or_b32 v4, v4, v7
    v_cmp_ne_u32 vcc, 0, v4
    s_add_u32 s101, s101, 1
    s_cmp_gt_u32 s101, 400000
    s_cbranch_scc1 L_A_done
    s_cbranch_vccnz L_A_loop
L_A_done:
    s_barrier
    s_mov_b32 s73, 0x100000
    s_mov_b32 s74, 0x300000
    buffer_load_dwordx4 v[36:39], v23, s[44:47], s73 offen sc1
    buffer_load_dwordx4 v[40:43], v24, s[44:47], s73 offen sc1
    buffer_load_dwordx4 v[44:47], v23, s[44:47], s74 offen sc1
    buffer_load_dwordx4 v[48:51], v24, s[44:47], s74 offen sc1
    buffer_load_dwordx4 v[52:55], v27, s[44:47], 0 offen offset:0 sc1
    buffer_load_dwordx4 v[56:59], v27, s[44:47], 0 offen offset:1024 sc1
    buffer_load_dwordx4 v[60:63], v27, s[44:47], 0 offen offset:2048 sc1
    buffer_load_dwordx4 v[64:67], v27, s[44:47], 0 offen offset:3072 sc1
    buffer_load_dwordx4 v[68:71], v28, s[44:47], 0 offen offset:0 sc1
    buffer_load_dwordx4 v[72:75], v28, s[44:47], 0 offen offset:1024 sc1
    buffer_load_dwordx4 v[76:79], v28, s[44:47], 0 offen offset:2048 sc1
    buffer_load_dwordx4 v[80:83], v28, s[44:47], 0 offen offset:3072 sc1
    buffer_load_ushort v84, v32, s[8:11], 0 offen
    s_waitcnt vmcnt(12)
    ds_write_b128 v25, v[36:39]
    s_waitcnt vmcnt(11)
    ds_write_b128 v26, v[40:43]
    s_waitcnt lgkmcnt(0)
    s_barrier
    ds_read_b128 v[120:123], v21 offset:0
    ds_read_b128 v[124:127], v22 offset:2480
    ds_read_b128 v[128:131], v22 offset:5040
    ds_read_b128 v[132:135], v21 offset:2048
    ds_read_b128 v[136:139], v21 offset:64
    ds_read_b128 v[140:143], v22 offset:2400
    ds_read_b128 v[144:147], v22 offset:4960
    ds_read_b128 v[148:151], v21 offset:2112
    ds_read_b128 v[152:155], v21 offset:128
    ds_read_b128 v[156:159], v22 offset:2320
    ds_read_b128 v[160:163], v22 offset:4880
    ds_read_b128 v[164:167], v21 offset:2176
    s_waitcnt lgkmcnt(10)
    v_mfma_f32_32x32x16_bf16 v[88:103], v[120:123], v[124:127], 0
    ds_read_b128 v[168:171], v21 offset:192
    ds_read_b128 v[172:175], v22 offset:2240
    s_waitcnt lgkmcnt(11)
    v_mfma_f32_32x32x16_bf16 v[104:119], v[120:123], v[128:131], 0
    ds_read_b128 v[176:179], v22 offset:4800
    ds_read_b128 v[180:183], v21 offset:2240
    s_waitcnt lgkmcnt(12)
    v_mfma_f32_32x32x16_bf16 v[104:119], v[132:135], v[124:127], v[104:119]
    s_waitcnt lgkmcnt(10)
    v_mfma_f32_32x32x16_bf16 v[88:103], v[136:139], v[140:143], v[88:103]
    ds_read_b128 v[120:123], v21 offset:256
    ds_read_b128 v[124:127], v22 offset:2160
    s_waitcnt lgkmcnt(11)
    v_mfma_f32_32x32x16_bf16 v[104:119], v[136:139], v[144:147], v[104:119]
    ds_read_b128 v[128:131], v22 offset:4720
    ds_read_b128 v[132:135], v21 offset:2304
    ds_read_b64_tr_b16 a[0:1], v17 offset:0
    ds_read_b64_tr_b16 a[2:3], v17 offset:256
    ds_read_b64_tr_b16 a[112:113], v18 offset:0
    s_waitcnt lgkmcnt(15)
    v_mfma_f32_32x32x16_bf16 v[104:119], v[148:151], v[140:143], v[104:119]
    ds_read_b64_tr_b16 a[114:115], v18 offset:256
    ds_read_b64_tr_b16 a[4:5], v17 offset:1024
    ds_read_b64_tr_b16 a[6:7], v17 offset:1280
    ds_read_b64_tr_b16 a[116:117], v18 offset:1024
    ds_read_b64_tr_b16 a[118:119], v18 offset:1280
    s_waitcnt lgkmcnt(15)
    v_mfma_f32_32x32x16_bf16 v[88:103], v[152:155], v[156:159], v[88:103]
    ds_read_b128 v[136:139], v21 offset:320
    ds_read_b128 v[140:143], v22 offset:2080
    s_waitcnt vmcnt(0)
    v_lshlrev_b32 v84, 16, v84
    v_lshlrev_b32 v184, 16, v44
    v_and_b32 v185, 0xffff0000, v44
    v_mfma_f32_32x32x16_bf16 v[104:119], v[152:155], v[160:163], v[104:119]
    ds_read_b128 v[144:147], v22 offset:4640
    ds_read_b128 v[148:151], v21 offset:2368
    v_lshlrev_b32 v186, 16, v45
    v_and_b32 v187, 0xffff0000, v45
    v_lshlrev_b32 v188, 16, v46
    v_mfma_f32_32x32x16_bf16 v[104:119], v[164:167], v[156:159], v[104:119]
    v_and_b32 v189, 0xffff0000, v46
    v_lshlrev_b32 v190, 16, v47
    v_and_b32 v191, 0xffff0000, v47
    v_lshlrev_b32 v223, 16, v36
    v_and_b32 v222, 0xffff0000, v36
    s_waitcnt lgkmcnt(15)
    v_mfma_f32_32x32x16_bf16 v[88:103], v[168:171], v[172:175], v[88:103]
    ds_read_b128 v[152:155], v21 offset:384
    ds_read_b128 v[156:159], v22 offset:2000
    s_waitcnt lgkmcnt(6)
    s_add_u32 m0, s94, 0
    s_add_u32 s72, s95, 344064
    buffer_load_dwordx4 v15, s[48:51], s72 offen lds
    v_mfma_f32_32x32x16_bf16 v[104:119], v[168:171], v[176:179], v[104:119]
    ds_read_b128 v[160:163], v22 offset:4560
    ds_read_b128 v[164:167], v21 offset:2432
    s_add_u32 m0, s94, 1024
    s_add_u32 s72, s95, 401408
    buffer_load_dwordx4 v15, s[48:51], s72 offen lds
    v_mfma_f32_32x32x16_bf16 v[104:119], v[180:183], v[172:175], v[104:119]
    s_add_u32 m0, s94, 2048
    s_add_u32 s72, s95, 344064
    buffer_load_dwordx4 v16, s[52:55], s72 offen lds
    v_lshlrev_b32 v221, 16, v37
    v_and_b32 v220, 0xffff0000, v37
    v_mfma_f32_32x32x16_bf16 v[88:103], v[120:123], v[124:127], v[88:103]
    ds_read_b128 v[168:171], v21 offset:448
    ds_read_b128 v[172:175], v22 offset:1920
    s_add_u32 m0, s94, 3072
    s_add_u32 s72, s95, 401408
    buffer_load_dwordx4 v16, s[52:55], s72 offen lds
    v_mfma_f32_32x32x16_bf16 v[104:119], v[120:123], v[128:131], v[104:119]
    ds_read_b128 v[176:179], v22 offset:4480
    ds_read_b128 v[180:183], v21 offset:2496
    v_lshlrev_b32 v219, 16, v38
    v_and_b32 v218, 0xffff0000, v38
    v_lshlrev_b32 v217, 16, v39
    v_mfma_f32_32x32x16_bf16 v[104:119], v[132:135], v[124:127], v[104:119]
    v_and_b32 v216, 0xffff0000, v39
    v_lshlrev_b32 v192, 16, v48
    v_and_b32 v193, 0xffff0000, v48
    v_lshlrev_b32 v194, 16, v49
    v_and_b32 v195, 0xffff0000, v49
    s_waitcnt lgkmcnt(10)
    v_mfma_f32_32x32x16_bf16 v[88:103], v[136:139], v[140:143], v[88:103]
    ds_read_b128 v[120:123], v21 offset:512
    ds_read_b128 v[124:127], v22 offset:1840
    ds_read_b64_tr_b16 a[8:9], v17 offset:4096
    ds_read_b64_tr_b16 a[10:11], v17 offset:4352
    ds_read_b64_tr_b16 a[120:121], v18 offset:4096
    s_waitcnt lgkmcnt(14)
    v_mfma_f32_32x32x16_bf16 v[104:119], v[136:139], v[144:147], v[104:119]
    ds_read_b128 v[128:131], v22 offset:4400
    ds_read_b128 v[132:135], v21 offset:2560
    ds_read_b64_tr_b16 a[122:123], v18 offset:4352
    ds_read_b64_tr_b16 a[12:13], v17 offset:5120
    ds_read_b64_tr_b16 a[14:15], v17 offset:5376
    s_waitcnt lgkmcnt(15)
    v_mfma_f32_32x32x16_bf16 v[104:119], v[148:151], v[140:143], v[104:119]
    ds_read_b64_tr_b16 a[124:125], v18 offset:5120
    ds_read_b64_tr_b16 a[126:127], v18 offset:5376
    v_lshlrev_b32 v196, 16, v50
    v_and_b32 v197, 0xffff0000, v50
    v_lshlrev_b32 v198, 16, v51
    v_mfma_f32_32x32x16_bf16 v[88:103], v[152:155], v[156:159], v[88:103]
    ds_read_b128 v[136:139], v21 offset:576
    ds_read_b128 v[140:143], v22 offset:1760
    v_and_b32 v199, 0xffff0000, v51
    v_lshlrev_b32 v231, 16, v40
    v_and_b32 v230, 0xffff0000, v40
    v_mfma_f32_32x32x16_bf16 v[104:119], v[152:155], v[160:163], v[104:119]
    ds_read_b128 v[144:147], v22 offset:4320
    ds_read_b128 v[148:151], v21 offset:2624
    v_lshlrev_b32 v229, 16, v41
    v_and_b32 v228, 0xffff0000, v41
    v_lshlrev_b32 v227, 16, v42
    s_waitcnt lgkmcnt(15)
    v_mfma_f32_32x32x16_bf16 v[104:119], v[164:167], v[156:159], v[104:119]
    s_waitcnt lgkmcnt(4)
    s_add_u32 m0, s94, 4096
    s_add_u32 s72, s95, 458752
    buffer_load_dwordx4 v15, s[48:51], s72 offen lds
    v_and_b32 v226, 0xffff0000, v42
    v_lshlrev_b32 v225, 16, v43
    v_mfma_f32_32x32x16_bf16 v[88:103], v[168:171], v[172:175], v[88:103]
    ds_read_b128 v[152:155], v21 offset:640
    ds_read_b128 v[156:159], v22 offset:1680
    s_add_u32 m0, s94, 5120
    s_add_u32 s72, s95, 516096
    buffer_load_dwordx4 v15, s[48:51], s72 offen lds
    v_mfma_f32_32x32x16_bf16 v[104:119], v[168:171], v[176:179], v[104:119]
    ds_read_b128 v[160:163], v22 offset:4240
    ds_read_b128 v[164:167], v21 offset:2688
    s_add_u32 m0, s94, 6144
    s_add_u32 s72, s95, 458752
    buffer_load_dwordx4 v16, s[52:55], s72 offen lds
    v_mfma_f32_32x32x16_bf16 v[104:119], v[180:183], v[172:175], v[104:119]
    s_add_u32 m0, s94, 7168
    s_add_u32 s72, s95, 516096
    buffer_load_dwordx4 v16, s[52:55], s72 offen lds
    v_and_b32 v224, 0xffff0000, v43
    v_mul_f32 v216, v84, v216
    v_mfma_f32_32x32x16_bf16 v[88:103], v[120:123], v[124:127], v[88:103]
    ds_read_b128 v[168:171], v21 offset:704
    ds_read_b128 v[172:175], v22 offset:1600
    v_mul_f32 v217, v84, v217
    v_mul_f32 v218, v84, v218
    v_mul_f32 v219, v84, v219
    v_mfma_f32_32x32x16_bf16 v[104:119], v[120:123], v[128:131], v[104:119]
    ds_read_b128 v[176:179], v22 offset:4160
    ds_read_b128 v[180:183], v21 offset:2752
    v_mul_f32 v220, v84, v220
    v_mul_f32 v221, v84, v221
    v_mul_f32 v222, v84, v222
    v_mfma_f32_32x32x16_bf16 v[104:119], v[132:135], v[124:127], v[104:119]
    ds_read_b64_tr_b16 a[16:17], v17 offset:8192
    ds_read_b64_tr_b16 a[18:19], v17 offset:8448
    ds_read_b64_tr_b16 a[128:129], v18 offset:8192
    ds_read_b64_tr_b16 a[130:131], v18 offset:8448
    s_waitcnt lgkmcnt(14)
    v_mfma_f32_32x32x16_bf16 v[88:103], v[136:139], v[140:143], v[88:103]
    ds_read_b128 v[120:123], v21 offset:768
    ds_read_b128 v[124:127], v22 offset:1520
    ds_read_b64_tr_b16 a[20:21], v17 offset:9216
    ds_read_b64_tr_b16 a[22:23], v17 offset:9472
    ds_read_b64_tr_b16 a[132:133], v18 offset:9216
    s_waitcnt lgkmcnt(15)
    v_mfma_f32_32x32x16_bf16 v[104:119], v[136:139], v[144:147], v[104:119]
    ds_read_b128 v[128:131], v22 offset:4080
    ds_read_b128 v[132:135], v21 offset:2816
    ds_read_b64_tr_b16 a[134:135], v18 offset:9472
    v_mul_f32 v223, v84, v223
    v_mul_f32 v224, v84, v224
    v_mfma_f32_32x32x16_bf16 v[104:119], v[148:151], v[140:143], v[104:119]
    v_mul_f32 v225, v84, v225
    v_mul_f32 v226, v84, v226
    v_mul_f32 v227, v84, v227
    v_mul_f32 v228, v84, v228
    v_mul_f32 v229, v84, v229
    v_mfma_f32_32x32x16_bf16 v[88:103], v[152:155], v[156:159], v[88:103]
    ds_read_b128 v[136:139], v21 offset:832
    ds_read_b128 v[140:143], v22 offset:1440
    v_mul_f32 v230, v84, v230
    v_mul_f32 v231, v84, v231
    v_fma_f32 v200, v184, v52, v53
    s_waitcnt lgkmcnt(15)
    v_mfma_f32_32x32x16_bf16 v[104:119], v[152:155], v[160:163], v[104:119]
    ds_read_b128 v[144:147], v22 offset:4000
    ds_read_b128 v[148:151], v21 offset:2880
    s_waitcnt lgkmcnt(4)
    s_add_u32 m0, s94, 8192
    s_add_u32 s72, s95, 573440
    buffer_load_dwordx4 v15, s[48:51], s72 offen lds
    v_mfma_f32_32x32x16_bf16 v[104:119], v[164:167], v[156:159], v[104:119]
    s_add_u32 m0, s94, 9216
    s_add_u32 s72, s95, 630784
    buffer_load_dwordx4 v15, s[48:51], s72 offen lds
    v_fma_f32 v201, v185, v54, v55
    v_fma_f32 v202, v186, v56, v57
    v_mfma_f32_32x32x16_bf16 v[88:103], v[168:171], v[172:175], v[88:103]
    ds_read_b128 v[152:155], v21 offset:896
    ds_read_b128 v[156:159], v22 offset:1360
    s_add_u32 m0, s94, 10240
    s_add_u32 s72, s95, 573440
    buffer_load_dwordx4 v16, s[52:55], s72 offen lds
    v_mfma_f32_32x32x16_bf16 v[104:119], v[168:171], v[176:179], v[104:119]
    ds_read_b128 v[160:163], v22 offset:3920
    ds_read_b128 v[164:167], v21 offset:2944
    s_add_u32 m0, s94, 11264
    s_add_u32 s72, s95, 630784
    buffer_load_dwordx4 v16, s[52:55], s72 offen lds
    v_mfma_f32_32x32x16_bf16 v[104:119], v[180:183], v[172:175], v[104:119]
    v_fma_f32 v203, v187, v58, v59
    v_fma_f32 v204, v188, v60, v61
    v_fma_f32 v205, v189, v62, v63
    v_fma_f32 v206, v190, v64, v65
    v_fma_f32 v207, v191, v66, v67
    v_mfma_f32_32x32x16_bf16 v[88:103], v[120:123], v[124:127], v[88:103]
    ds_read_b128 v[168:171], v21 offset:960
    ds_read_b128 v[172:175], v22 offset:1280
    v_fma_f32 v208, v192, v68, v69
    v_fma_f32 v209, v193, v70, v71
    v_fma_f32 v210, v194, v72, v73
    v_mfma_f32_32x32x16_bf16 v[104:119], v[120:123], v[128:131], v[104:119]
    ds_read_b128 v[176:179], v22 offset:3840
    ds_read_b128 v[180:183], v21 offset:3008
    s_waitcnt vmcnt(8)
    ds_read_b64_tr_b16 a[24:25], v17 offset:0
    ds_read_b64_tr_b16 a[26:27], v17 offset:256
    ds_read_b64_tr_b16 a[136:137], v18 offset:0
    v_mfma_f32_32x32x16_bf16 v[104:119], v[132:135], v[124:127], v[104:119]
    ds_read_b64_tr_b16 a[138:139], v18 offset:256
    ds_read_b64_tr_b16 a[28:29], v17 offset:1024
    ds_read_b64_tr_b16 a[30:31], v17 offset:1280
    ds_read_b64_tr_b16 a[140:141], v18 offset:1024
    ds_read_b64_tr_b16 a[142:143], v18 offset:1280
    s_waitcnt lgkmcnt(15)
    v_mfma_f32_32x32x16_bf16 v[88:103], v[136:139], v[140:143], v[88:103]
    ds_read_b128 v[120:123], v21 offset:1024
    ds_read_b128 v[124:127], v22 offset:1200
    v_fma_f32 v211, v195, v74, v75
    v_fma_f32 v212, v196, v76, v77
    v_fma_f32 v213, v197, v78, v79
    v_mfma_f32_32x32x16_bf16 v[104:119], v[136:139], v[144:147], v[104:119]
    ds_read_b128 v[128:131], v22 offset:3760
    ds_read_b128 v[132:135], v21 offset:3072
    v_fma_f32 v214, v198, v80, v81
    v_fma_f32 v215, v199, v82, v83
    v_fma_f32 v184, v200, v216, v184
    v_mfma_f32_32x32x16_bf16 v[104:119], v[148:151], v[140:143], v[104:119]
    v_fma_f32 v185, v201, v217, v185
    v_fma_f32 v186, v202, v218, v186
    v_fma_f32 v187, v203, v219, v187
    v_fma_f32 v188, v204, v220, v188
    v_fma_f32 v189, v205, v221, v189
    s_waitcnt lgkmcnt(15)
    v_mfma_f32_32x32x16_bf16 v[88:103], v[152:155], v[156:159], v[88:103]
    ds_read_b128 v[136:139], v21 offset:1088
    ds_read_b128 v[140:143], v22 offset:1120
    s_waitcnt lgkmcnt(6)
    s_add_u32 m0, s94, 0
    s_add_u32 s72, s95, 688128
    buffer_load_dwordx4 v15, s[48:51], s72 offen lds
    v_mfma_f32_32x32x16_bf16 v[104:119], v[152:155], v[160:163], v[104:119]
    ds_read_b128 v[144:147], v22 offset:3680
    ds_read_b128 v[148:151], v21 offset:3136
    s_add_u32 m0, s94, 1024
    s_add_u32 s72, s95, 745472
    buffer_load_dwordx4 v15, s[48:51], s72 offen lds
    v_mfma_f32_32x32x16_bf16 v[104:119], v[164:167], v[156:159], v[104:119]
    s_add_u32 m0, s94, 2048
    s_add_u32 s72, s95, 688128
    buffer_load_dwordx4 v16, s[52:55], s72 offen lds
    v_fma_f32 v190, v206, v222, v190
    v_fma_f32 v191, v207, v223, v191
    v_mfma_f32_32x32x16_bf16 v[88:103], v[168:171], v[172:175], v[88:103]
    ds_read_b128 v[152:155], v21 offset:1152
    ds_read_b128 v[156:159], v22 offset:1040
    s_add_u32 m0, s94, 3072
    s_add_u32 s72, s95, 745472
    buffer_load_dwordx4 v16, s[52:55], s72 offen lds
    v_mfma_f32_32x32x16_bf16 v[104:119], v[168:171], v[176:179], v[104:119]
    ds_read_b128 v[160:163], v22 offset:3600
    ds_read_b128 v[164:167], v21 offset:3200
    v_fma_f32 v192, v208, v224, v192
    v_fma_f32 v193, v209, v225, v193
    v_fma_f32 v194, v210, v226, v194
    v_mfma_f32_32x32x16_bf16 v[104:119], v[180:183], v[172:175], v[104:119]
    v_fma_f32 v195, v211, v227, v195
    v_fma_f32 v196, v212, v228, v196
    v_fma_f32 v197, v213, v229, v197
    v_fma_f32 v198, v214, v230, v198
    v_fma_f32 v199, v215, v231, v199
    s_waitcnt lgkmcnt(10)
    v_mfma_f32_32x32x16_bf16 v[88:103], v[120:123], v[124:127], v[88:103]
    ds_read_b128 v[168:171], v21 offset:1216
    ds_read_b128 v[172:175], v22 offset:960
    s_waitcnt vmcnt(8)
    ds_read_b64_tr_b16 a[32:33], v17 offset:4096
    ds_read_b64_tr_b16 a[34:35], v17 offset:4352
    s_waitcnt lgkmcnt(13)
    v_mfma_f32_32x32x16_bf16 v[104:119], v[120:123], v[128:131], v[104:119]
    ds_read_b128 v[176:179], v22 offset:3520
    ds_read_b128 v[180:183], v21 offset:3264
    ds_read_b64_tr_b16 a[144:145], v18 offset:4096
    ds_read_b64_tr_b16 a[146:147], v18 offset:4352
    ds_read_b64_tr_b16 a[36:37], v17 offset:5120
    s_waitcnt lgkmcnt(15)
    v_mfma_f32_32x32x16_bf16 v[104:119], v[132:135], v[124:127], v[104:119]
    ds_read_b64_tr_b16 a[38:39], v17 offset:5376
    ds_read_b64_tr_b16 a[148:149], v18 offset:5120
    ds_read_b64_tr_b16 a[150:151], v18 offset:5376
    v_mfma_f32_32x32x16_bf16 v[88:103], v[136:139], v[140:143], v[88:103]
    ds_read_b128 v[120:123], v21 offset:1280
    ds_read_b128 v[124:127], v22 offset:880
    s_waitcnt lgkmcnt(15)
    v_mfma_f32_32x32x16_bf16 v[104:119], v[136:139], v[144:147], v[104:119]
    ds_read_b128 v[128:131], v22 offset:3440
    ds_read_b128 v[132:135], v21 offset:3328
    v_mfma_f32_32x32x16_bf16 v[104:119], v[148:151], v[140:143], v[104:119]
    s_waitcnt lgkmcnt(4)
    s_add_u32 m0, s94, 4096
    s_add_u32 s72, s95, 802816
    buffer_load_dwordx4 v15, s[48:51], s72 offen lds
    v_mfma_f32_32x32x16_bf16 v[88:103], v[152:155], v[156:159], v[88:103]
    ds_read_b128 v[136:139], v21 offset:1344
    ds_read_b128 v[140:143], v22 offset:800
    s_add_u32 m0, s94, 5120
    s_add_u32 s72, s95, 860160
    buffer_load_dwordx4 v15, s[48:51], s72 offen lds
    v_mfma_f32_32x32x16_bf16 v[104:119], v[152:155], v[160:163], v[104:119]
    ds_read_b128 v[144:147], v22 offset:3360
    ds_read_b128 v[148:151], v21 offset:3392
    s_add_u32 m0, s94, 6144
    s_add_u32 s72, s95, 802816
    buffer_load_dwordx4 v16, s[52:55], s72 offen lds
    v_mfma_f32_32x32x16_bf16 v[104:119], v[164:167], v[156:159], v[104:119]
    s_add_u32 m0, s94, 7168
    s_add_u32 s72, s95, 860160
    buffer_load_dwordx4 v16, s[52:55], s72 offen lds
    v_mfma_f32_32x32x16_bf16 v[88:103], v[168:171], v[172:175], v[88:103]
    ds_read_b128 v[152:155], v21 offset:1408
    ds_read_b128 v[156:159], v22 offset:720
    v_mfma_f32_32x32x16_bf16 v[104:119], v[168:171], v[176:179], v[104:119]
    ds_read_b128 v[160:163], v22 offset:3280
    ds_read_b128 v[164:167], v21 offset:3456
    v_mfma_f32_32x32x16_bf16 v[104:119], v[180:183], v[172:175], v[104:119]
    s_waitcnt vmcnt(8)
    ds_read_b64_tr_b16 a[40:41], v17 offset:8192
    ds_read_b64_tr_b16 a[42:43], v17 offset:8448
    ds_read_b64_tr_b16 a[152:153], v18 offset:8192
    ds_read_b64_tr_b16 a[154:155], v18 offset:8448
    ds_read_b64_tr_b16 a[44:45], v17 offset:9216
    s_waitcnt lgkmcnt(15)
    v_mfma_f32_32x32x16_bf16 v[88:103], v[120:123], v[124:127], v[88:103]
    ds_read_b128 v[168:171], v21 offset:1472
    ds_read_b128 v[172:175], v22 offset:640
    ds_read_b64_tr_b16 a[46:47], v17 offset:9472
    ds_read_b64_tr_b16 a[156:157], v18 offset:9216
    ds_read_b64_tr_b16 a[158:159], v18 offset:9472
    s_waitcnt lgkmcnt(15)
    v_mfma_f32_32x32x16_bf16 v[104:119], v[120:123], v[128:131], v[104:119]
    ds_read_b128 v[176:179], v22 offset:3200
    ds_read_b128 v[180:183], v21 offset:3520
    v_mfma_f32_32x32x16_bf16 v[104:119], v[132:135], v[124:127], v[104:119]
    v_mfma_f32_32x32x16_bf16 v[88:103], v[136:139], v[140:143], v[88:103]
    ds_read_b128 v[120:123], v21 offset:1536
    ds_read_b128 v[124:127], v22 offset:560
    v_mfma_f32_32x32x16_bf16 v[104:119], v[136:139], v[144:147], v[104:119]
    ds_read_b128 v[128:131], v22 offset:3120
    ds_read_b128 v[132:135], v21 offset:3584
    s_waitcnt lgkmcnt(6)
    s_add_u32 m0, s94, 8192
    s_add_u32 s72, s95, 917504
    buffer_load_dwordx4 v15, s[48:51], s72 offen lds
    v_mfma_f32_32x32x16_bf16 v[104:119], v[148:151], v[140:143], v[104:119]
    s_add_u32 m0, s94, 9216
    s_add_u32 s72, s95, 974848
    buffer_load_dwordx4 v15, s[48:51], s72 offen lds
    v_mfma_f32_32x32x16_bf16 v[88:103], v[152:155], v[156:159], v[88:103]
    ds_read_b128 v[136:139], v21 offset:1600
    ds_read_b128 v[140:143], v22 offset:480
    s_add_u32 m0, s94, 10240
    s_add_u32 s72, s95, 917504
    buffer_load_dwordx4 v16, s[52:55], s72 offen lds
    v_mfma_f32_32x32x16_bf16 v[104:119], v[152:155], v[160:163], v[104:119]
    ds_read_b128 v[144:147], v22 offset:3040
    ds_read_b128 v[148:151], v21 offset:3648
    s_add_u32 m0, s94, 11264
    s_add_u32 s72, s95, 974848
    buffer_load_dwordx4 v16, s[52:55], s72 offen lds
    v_mfma_f32_32x32x16_bf16 v[104:119], v[164:167], v[156:159], v[104:119]
    v_mfma_f32_32x32x16_bf16 v[88:103], v[168:171], v[172:175], v[88:103]
    ds_read_b128 v[152:155], v21 offset:1664
    ds_read_b128 v[156:159], v22 offset:400
    s_waitcnt lgkmcnt(11)
    v_mfma_f32_32x32x16_bf16 v[104:119], v[168:171], v[176:179], v[104:119]
    ds_read_b128 v[160:163], v22 offset:2960
    ds_read_b128 v[164:167], v21 offset:3712
    s_waitcnt vmcnt(8)
    ds_read_b64_tr_b16 a[48:49], v17 offset:0
    ds_read_b64_tr_b16 a[50:51], v17 offset:256
    ds_read_b64_tr_b16 a[160:161], v18 offset:0
    s_waitcnt lgkmcnt(15)
    v_mfma_f32_32x32x16_bf16 v[104:119], v[180:183], v[172:175], v[104:119]
    ds_read_b64_tr_b16 a[162:163], v18 offset:256
    ds_read_b64_tr_b16 a[52:53], v17 offset:1024
    ds_read_b64_tr_b16 a[54:55], v17 offset:1280
    ds_read_b64_tr_b16 a[164:165], v18 offset:1024
    ds_read_b64_tr_b16 a[166:167], v18 offset:1280
    s_waitcnt lgkmcnt(15)
    v_mfma_f32_32x32x16_bf16 v[88:103], v[120:123], v[124:127], v[88:103]
    ds_read_b128 v[168:171], v21 offset:1728
    ds_read_b128 v[172:175], v22 offset:320
    v_mfma_f32_32x32x16_bf16 v[104:119], v[120:123], v[128:131], v[104:119]
    ds_read_b128 v[176:179], v22 offset:2880
    ds_read_b128 v[180:183], v21 offset:3776
    v_mfma_f32_32x32x16_bf16 v[104:119], v[132:135], v[124:127], v[104:119]
    s_waitcnt lgkmcnt(15)
    v_mfma_f32_32x32x16_bf16 v[88:103], v[136:139], v[140:143], v[88:103]
    ds_read_b128 v[120:123], v21 offset:1792
    ds_read_b128 v[124:127], v22 offset:240
    s_waitcnt lgkmcnt(6)
    s_add_u32 m0, s94, 0
    s_add_u32 s72, s95, 1032192
    buffer_load_dwordx4 v15, s[48:51], s72 offen lds
    v_mfma_f32_32x32x16_bf16 v[104:119], v[136:139], v[144:147], v[104:119]
    ds_read_b128 v[128:131], v22 offset:2800
    ds_read_b128 v[132:135], v21 offset:3840
    s_add_u32 m0, s94, 1024
    s_add_u32 s72, s95, 1089536
    buffer_load_dwordx4 v15, s[48:51], s72 offen lds
    v_mfma_f32_32x32x16_bf16 v[104:119], v[148:151], v[140:143], v[104:119]
    s_add_u32 m0, s94, 2048
    s_add_u32 s72, s95, 1032192
    buffer_load_dwordx4 v16, s[52:55], s72 offen lds
    v_mfma_f32_32x32x16_bf16 v[88:103], v[152:155], v[156:159], v[88:103]
    ds_read_b128 v[136:139], v21 offset:1856
    ds_read_b128 v[140:143], v22 offset:160
    s_add_u32 m0, s94, 3072
    s_add_u32 s72, s95, 1089536
    buffer_load_dwordx4 v16, s[52:55], s72 offen lds
    v_mfma_f32_32x32x16_bf16 v[104:119], v[152:155], v[160:163], v[104:119]
    ds_read_b128 v[144:147], v22 offset:2720
    ds_read_b128 v[148:151], v21 offset:3904
    v_mfma_f32_32x32x16_bf16 v[104:119], v[164:167], v[156:159], v[104:119]
    s_waitcnt lgkmcnt(10)
    v_mfma_f32_32x32x16_bf16 v[88:103], v[168:171], v[172:175], v[88:103]
    ds_read_b128 v[152:155], v21 offset:1920
    ds_read_b128 v[156:159], v22 offset:80
    s_waitcnt lgkmcnt(11)
    v_mfma_f32_32x32x16_bf16 v[104:119], v[168:171], v[176:179], v[104:119]
    ds_read_b128 v[160:163], v22 offset:2640
    ds_read_b128 v[164:167], v21 offset:3968
    s_waitcnt lgkmcnt(12)
    v_mfma_f32_32x32x16_bf16 v[104:119], v[180:183], v[172:175], v[104:119]
    s_waitcnt lgkmcnt(10)
    v_mfma_f32_32x32x16_bf16 v[88:103], v[120:123], v[124:127], v[88:103]
    ds_read_b128 v[168:171], v21 offset:1984
    ds_read_b128 v[172:175], v22 offset:0
    s_waitcnt lgkmcnt(11)
    v_mfma_f32_32x32x16_bf16 v[104:119], v[120:123], v[128:131], v[104:119]
    ds_read_b128 v[176:179], v22 offset:2560
    ds_read_b128 v[180:183], v21 offset:4032
    s_waitcnt lgkmcnt(12)
    v_mfma_f32_32x32x16_bf16 v[104:119], v[132:135], v[124:127], v[104:119]
    s_cmp_eq_u32 s85, 0
    s_cbranch_scc0 L_p1_ks1
    s_waitcnt lgkmcnt(9)
    v_mfma_f32_32x32x16_bf16 v[104:119], v[136:139], v[144:147], v[104:119]
    s_waitcnt lgkmcnt(8)
    v_mfma_f32_32x32x16_bf16 v[104:119], v[148:151], v[140:143], v[104:119]
    s_waitcnt lgkmcnt(5)
    v_mfma_f32_32x32x16_bf16 v[104:119], v[152:155], v[160:163], v[104:119]
    s_waitcnt lgkmcnt(4)
    v_mfma_f32_32x32x16_bf16 v[104:119], v[164:167], v[156:159], v[104:119]
    s_waitcnt lgkmcnt(1)
    v_mfma_f32_32x32x16_bf16 v[104:119], v[168:171], v[176:179], v[104:119]
    s_waitcnt lgkmcnt(0)
    v_mfma_f32_32x32x16_bf16 v[104:119], v[180:183], v[172:175], v[104:119]
    v_mfma_f32_32x32x16_bf16 v[88:103], v[136:139], v[140:143], v[88:103]
    v_mfma_f32_32x32x16_bf16 v[88:103], v[152:155], v[156:159], v[88:103]
    s_nop 9
    ds_write_b128 v30, v[104:107] offset:0
    ds_write_b128 v30, v[108:111] offset:1024
    ds_write_b128 v30, v[112:115] offset:2048
    ds_write_b128 v30, v[116:119] offset:3072
    v_mfma_f32_32x32x16_bf16 v[88:103], v[168:171], v[172:175], v[88:103]
    s_waitcnt lgkmcnt(0)
    s_barrier
    ds_read_b128 v[120:123], v31 offset:0
    ds_read_b128 v[124:127], v31 offset:1024
    ds_read_b128 v[128:131], v31 offset:2048
    ds_read_b128 v[132:135], v31 offset:3072
    s_waitcnt lgkmcnt(3)
    s_nop 4
    v_pk_add_f32 v[120:121], v[120:121], v[88:89]
    v_pk_add_f32 v[122:123], v[122:123], v[90:91]
    s_waitcnt lgkmcnt(2)
    v_pk_add_f32 v[124:125], v[124:125], v[92:93]
    v_pk_add_f32 v[126:127], v[126:127], v[94:95]
    s_waitcnt lgkmcnt(1)
    v_pk_add_f32 v[128:129], v[128:129], v[96:97]
    v_pk_add_f32 v[130:131], v[130:131], v[98:99]
    s_waitcnt lgkmcnt(0)
    v_pk_add_f32 v[132:133], v[132:133], v[100:101]
    v_pk_add_f32 v[134:135], v[134:135], v[102:103]
    s_branch L_p1_join
L_p1_ks1:
    s_waitcnt lgkmcnt(10)
    v_mfma_f32_32x32x16_bf16 v[88:103], v[136:139], v[140:143], v[88:103]
    s_waitcnt lgkmcnt(6)
    v_mfma_f32_32x32x16_bf16 v[88:103], v[152:155], v[156:159], v[88:103]
    s_waitcnt lgkmcnt(2)
    v_mfma_f32_32x32x16_bf16 v[88:103], v[168:171], v[172:175], v[88:103]
    v_mfma_f32_32x32x16_bf16 v[104:119], v[136:139], v[144:147], v[104:119]
    v_mfma_f32_32x32x16_bf16 v[104:119], v[148:151], v[140:143], v[104:119]
    s_nop 9
    ds_write_b128 v30, v[88:91] offset:0
    ds_write_b128 v30, v[92:95] offset:1024
    ds_write_b128 v30, v[96:99] offset:2048
    ds_write_b128 v30, v[100:103] offset:3072
    v_mfma_f32_32x32x16_bf16 v[104:119], v[152:155], v[160:163], v[104:119]
    v_mfma_f32_32x32x16_bf16 v[104:119], v[164:167], v[156:159], v[104:119]
    s_waitcnt lgkmcnt(5)
    v_mfma_f32_32x32x16_bf16 v[104:119], v[168:171], v[176:179], v[104:119]
    s_waitcnt lgkmcnt(4)
    v_mfma_f32_32x32x16_bf16 v[104:119], v[180:183], v[172:175], v[104:119]
    s_waitcnt lgkmcnt(0)
    s_barrier
    ds_read_b128 v[120:123], v31 offset:0
    ds_read_b128 v[124:127], v31 offset:1024
    ds_read_b128 v[128:131], v31 offset:2048
    ds_read_b128 v[132:135], v31 offset:3072
    s_waitcnt lgkmcnt(3)
    s_nop 4
    v_pk_add_f32 v[120:121], v[120:121], v[104:105]
    v_pk_add_f32 v[122:123], v[122:123], v[106:107]
    s_waitcnt lgkmcnt(2)
    v_pk_add_f32 v[124:125], v[124:125], v[108:109]
    v_pk_add_f32 v[126:127], v[126:127], v[110:111]
    s_waitcnt lgkmcnt(1)
    v_pk_add_f32 v[128:129], v[128:129], v[112:113]
    v_pk_add_f32 v[130:131], v[130:131], v[114:115]
    s_waitcnt lgkmcnt(0)
    v_pk_add_f32 v[132:133], v[132:133], v[116:117]
    v_pk_add_f32 v[134:135], v[134:135], v[118:119]
L_p1_join:
    v_pk_fma_f32 v[136:137], v[200:201], v[120:121], v[184:185]
    v_pk_fma_f32 v[138:139], v[202:203], v[122:123], v[186:187]
    v_pk_fma_f32 v[140:141], v[204:205], v[132:133], v[188:189]
    v_pk_fma_f32 v[142:143], v[206:207], v[134:135], v[190:191]
    v_pk_fma_f32 v[144:145], v[208:209], v[124:125], v[192:193]
    v_pk_fma_f32 v[146:147], v[210:211], v[126:127], v[194:195]
    v_pk_fma_f32 v[148:149], v[212:213], v[128:129], v[196:197]
    v_pk_fma_f32 v[150:151], v[214:215], v[130:131], v[198:199]
    v_cvt_pk_bf16_f32 v152, v136, v137
    v_cvt_pk_bf16_f32 v153, v138, v139
    v_cvt_pk_bf16_f32 v154, v140, v141
    v_cvt_pk_bf16_f32 v155, v142, v143
    v_cvt_pk_bf16_f32 v156, v144, v145
    v_cvt_pk_bf16_f32 v157, v146, v147
    v_cvt_pk_bf16_f32 v158, v148, v149
    v_cvt_pk_bf16_f32 v159, v150, v151
    v_permlane16_swap_b32 v152, v156
    v_permlane16_swap_b32 v153, v157
    v_permlane16_swap_b32 v154, v158
    v_permlane16_swap_b32 v155, v159
    buffer_store_dwordx4 v[152:155], v29, s[44:47], 0 offen sc1
    buffer_store_dwordx4 v[156:159], v29, s[44:47], 0 offen offset:1024 sc1
    v_and_b32 v22, 63, v0
    v_lshrrev_b32 v23, 3, v22
    v_lshlrev_b32 v21, 12, v23
    v_bfe_u32 v23, v22, 2, 1
    v_lshrrev_b32 v22, 4, v22
    v_xor_b32 v23, v23, v22
    v_and_b32 v23, 1, v23
    v_lshl_add_u32 v21, v23, 6, v21
    v_and_b32 v23, 3, v0
    v_lshl_add_u32 v21, v23, 4, v21
    s_lshl_b32 s76, s86, 8
    s_lshl_b32 s72, s88, 15
    s_add_u32 s76, s76, s72
    s_add_u32 s76, s76, 0x500000
    s_lshl_b32 s77, s88, 10
    v_and_b32 v26, 63, v0
    v_bfe_u32 v27, v26, 2, 2
    v_lshlrev_b32 v22, 7, v27
    v_lshrrev_b32 v27, 5, v26
    v_lshl_add_u32 v22, v27, 10, v22
    v_bfe_u32 v27, v26, 3, 1
    v_lshl_add_u32 v22, v27, 6, v22
    v_bfe_u32 v27, v26, 4, 1
    v_lshl_add_u32 v22, v27, 5, v22
    v_and_b32 v27, 3, v26
    v_lshl_add_u32 v22, v27, 3, v22
    v_xor_b32 v23, 64, v22
    v_add_u32 v24, 57344, v22
    v_add_u32 v25, 57344, v23
    v_and_b32 v33, 63, v0
    v_lshrrev_b32 v34, 3, v33
    v_mul_u32_u24 v26, 896, v34
    v_bfe_u32 v34, v33, 2, 1
    v_bfe_u32 v35, v33, 4, 1
    v_xor_b32 v34, v34, v35
    v_lshl_add_u32 v26, v34, 6, v26
    v_and_b32 v34, 3, v33
    v_lshl_add_u32 v26, v34, 4, v26
    v_bfe_u32 v34, v33, 2, 2
    v_lshlrev_b32 v35, 7, v34
    v_lshrrev_b32 v34, 5, v33
    v_lshl_add_u32 v35, v34, 9, v35
    v_bfe_u32 v34, v33, 3, 1
    v_lshl_add_u32 v35, v34, 6, v35
    v_bfe_u32 v34, v33, 4, 1
    v_lshl_add_u32 v35, v34, 5, v35
    v_and_b32 v34, 3, v33
    v_lshl_add_u32 v35, v34, 3, v35
    s_mul_i32 s78, s88, 12288
    s_add_u32 s78, s78, 114688
    v_add_u32 v27, s78, v35
    v_xor_b32 v28, 64, v27
    s_mul_i32 s79, s88, 12288
    s_add_u32 s79, s79, 0
    v_add_u32 v29, s79, v35
    v_xor_b32 v30, 64, v29
    s_mul_i32 s80, s88, 12288
    s_add_u32 s80, s80, 57344
    v_add_u32 v31, s80, v35
    v_xor_b32 v32, 64, v31
    s_mul_i32 s83, s88, 401408
    s_lshl_b32 s72, s91, 7
    s_add_u32 s83, s83, s72
    v_and_b32 v41, 63, v0
    v_lshrrev_b32 v39, 2, v41
    v_lshlrev_b32 v33, 12, v39
    v_and_b32 v39, 3, v41
    v_lshl_add_u32 v33, v39, 4, v33
    v_lshlrev_b32 v34, 4, v41
    s_lshr_b32 s72, s90, 1
    s_lshl_b32 s72, s72, 2
    s_and_b32 s73, s90, 1
    s_add_u32 s92, s72, s73
    v_and_b32 v39, 31, v41
    v_mul_u32_u24 v35, 272, v39
    v_lshrrev_b32 v39, 5, v41
    v_lshl_add_u32 v35, v39, 4, v35
    s_mul_i32 s72, s88, 8704
    s_add_u32 s72, s72, 57344
    v_add_u32 v35, s72, v35
    s_and_b32 s72, s88, 1
    s_lshl_b32 s72, s72, 4
    v_and_b32 v39, 15, v41
    v_add_u32 v39, s72, v39
    v_mul_u32_u24 v36, 272, v39
    v_mul_u32_u24 v38, 896, v39
    v_lshrrev_b32 v40, 4, v41
    v_lshl_add_u32 v36, v40, 5, v36
    v_lshl_add_u32 v38, v40, 4, v38
    s_lshr_b32 s72, s88, 1
    s_lshl_b32 s73, s72, 7
    s_add_u32 s73, s73, 57344
    v_add_u32 v36, s73, v36
    s_lshl_b32 s72, s72, 6
    s_lshl_b32 s73, s91, 7
    s_add_u32 s72, s72, s73
    s_mul_i32 s73, s92, 28672
    s_add_u32 s72, s72, s73
    v_add_u32 v38, s72, v38
    v_lshlrev_b32 v37, 9, v40
    v_bfe_u32 v39, v41, 2, 2
    v_lshl_add_u32 v37, v39, 6, v37
    v_and_b32 v39, 3, v41
    v_lshl_add_u32 v37, v39, 3, v37
    s_lshr_b32 s72, s88, 1
    s_lshl_b32 s72, s72, 11
    s_and_b32 s73, s88, 1
    s_lshl_b32 s73, s73, 5
    s_add_u32 s72, s72, s73
    s_add_u32 s72, s72, 49152
    v_add_u32 v37, s72, v37
    s_mul_i32 s30, s92, 113
    s_mul_i32 s72, s88, 28
    s_add_u32 s30, s30, s72
    s_lshl_b32 s30, s30, 10
    s_add_u32 s30, s30, 0x700000
    s_lshl_b32 s72, s91, 18
    s_lshl_b32 s73, s88, 16
    s_add_u32 s72, s72, s73
    s_lshl_b32 s73, s92, 6
    s_add_u32 s72, s72, s73
    s_add_u32 s31, s72, 0x500000
    s_lshl_b32 s73, s88, 10
    s_add_u32 s17, s73, 49152
    s_mul_i32 s16, s92, 115712
    s_lshl_b32 s72, s91, 14
    s_add_u32 s16, s16, s72
    s_lshl_b32 s72, s88, 12
    s_add_u32 s16, s16, s72
    s_add_u32 s16, s16, 0x700000
    s_waitcnt vmcnt(0)
    s_barrier
    s_mov_b32 s100, 0x9000
    v_mov_b32 v4, s93
    buffer_store_dword v4, v9, s[44:47], s100 offen sc1
    s_add_u32 m0, s81, 0
    s_add_u32 s72, s95, 1146880
    buffer_load_dwordx4 v15, s[48:51], s72 offen lds
    s_add_u32 m0, s81, 1024
    s_add_u32 s72, s95, 1204224
    buffer_load_dwordx4 v15, s[48:51], s72 offen lds
    s_add_u32 m0, s81, 2048
    s_add_u32 s72, s95, 1146880
    buffer_load_dwordx4 v16, s[52:55], s72 offen lds
    s_add_u32 m0, s81, 3072
    s_add_u32 s72, s95, 1204224
    buffer_load_dwordx4 v16, s[52:55], s72 offen lds
    s_add_u32 m0, s81, 4096
    s_add_u32 s72, s95, 1261568
    buffer_load_dwordx4 v15, s[48:51], s72 offen lds
    s_add_u32 m0, s81, 5120
    s_add_u32 s72, s95, 1318912
    buffer_load_dwordx4 v15, s[48:51], s72 offen lds
    s_add_u32 m0, s81, 6144
    s_add_u32 s72, s95, 1261568
    buffer_load_dwordx4 v16, s[52:55], s72 offen lds
    s_add_u32 m0, s81, 7168
    s_add_u32 s72, s95, 1318912
    buffer_load_dwordx4 v16, s[52:55], s72 offen lds
    s_add_u32 m0, s81, 8192
    s_add_u32 s72, s95, 1376256
    buffer_load_dwordx4 v15, s[48:51], s72 offen lds
    s_add_u32 m0, s81, 9216
    s_add_u32 s72, s95, 1433600
    buffer_load_dwordx4 v15, s[48:51], s72 offen lds
    s_add_u32 m0, s81, 10240
    s_add_u32 s72, s95, 1376256
    buffer_load_dwordx4 v16, s[52:55], s72 offen lds
    s_add_u32 m0, s81, 11264
    s_add_u32 s72, s95, 1433600
    buffer_load_dwordx4 v16, s[52:55], s72 offen lds
    s_add_u32 m0, s81, 12288
    s_add_u32 s72, s95, 1490944
    buffer_load_dwordx4 v15, s[48:51], s72 offen lds
    s_add_u32 m0, s81, 13312
    s_add_u32 s72, s95, 1548288
    buffer_load_dwordx4 v15, s[48:51], s72 offen lds
    s_add_u32 m0, s81, 14336
    s_add_u32 s72, s95, 1490944
    buffer_load_dwordx4 v16, s[52:55], s72 offen lds
    s_add_u32 m0, s81, 15360
    s_add_u32 s72, s95, 1548288
    buffer_load_dwordx4 v16, s[52:55], s72 offen lds
    ds_read_b64_tr_b16 a[56:57], v17 offset:4096
    ds_read_b64_tr_b16 a[58:59], v17 offset:4352
    ds_read_b64_tr_b16 a[168:169], v18 offset:4096
    ds_read_b64_tr_b16 a[170:171], v18 offset:4352
    ds_read_b64_tr_b16 a[60:61], v17 offset:5120
    ds_read_b64_tr_b16 a[62:63], v17 offset:5376
    ds_read_b64_tr_b16 a[172:173], v18 offset:5120
    ds_read_b64_tr_b16 a[174:175], v18 offset:5376
    ds_read_b64_tr_b16 a[64:65], v17 offset:8192
    ds_read_b64_tr_b16 a[66:67], v17 offset:8448
    ds_read_b64_tr_b16 a[176:177], v18 offset:8192
    ds_read_b64_tr_b16 a[178:179], v18 offset:8448
    ds_read_b64_tr_b16 a[68:69], v17 offset:9216
    ds_read_b64_tr_b16 a[70:71], v17 offset:9472
    ds_read_b64_tr_b16 a[180:181], v18 offset:9216
    ds_read_b64_tr_b16 a[182:183], v18 offset:9472
    ds_read_b64_tr_b16 a[72:73], v17 offset:0
    ds_read_b64_tr_b16 a[74:75], v17 offset:256
    ds_read_b64_tr_b16 a[184:185], v18 offset:0
    ds_read_b64_tr_b16 a[186:187], v18 offset:256
    ds_read_b64_tr_b16 a[76:77], v17 offset:1024
    ds_read_b64_tr_b16 a[78:79], v17 offset:1280
    ds_read_b64_tr_b16 a[188:189], v18 offset:1024
    ds_read_b64_tr_b16 a[190:191], v18 offset:1280
    s_waitcnt vmcnt(12)
    ds_read_b64_tr_b16 a[80:81], v19 offset:0
    ds_read_b64_tr_b16 a[82:83], v19 offset:256
    ds_read_b64_tr_b16 a[192:193], v20 offset:0
    ds_read_b64_tr_b16 a[194:195], v20 offset:256
    ds_read_b64_tr_b16 a[84:85], v19 offset:1024
    ds_read_b64_tr_b16 a[86:87], v19 offset:1280
    ds_read_b64_tr_b16 a[196:197], v20 offset:1024
    ds_read_b64_tr_b16 a[198:199], v20 offset:1280
    s_waitcnt vmcnt(8)
    ds_read_b64_tr_b16 a[88:89], v19 offset:4096
    ds_read_b64_tr_b16 a[90:91], v19 offset:4352
    ds_read_b64_tr_b16 a[200:201], v20 offset:4096
    ds_read_b64_tr_b16 a[202:203], v20 offset:4352
    ds_read_b64_tr_b16 a[92:93], v19 offset:5120
    ds_read_b64_tr_b16 a[94:95], v19 offset:5376
    ds_read_b64_tr_b16 a[204:205], v20 offset:5120
    ds_read_b64_tr_b16 a[206:207], v20 offset:5376
    s_mov_b32 s100, 0x9000
    buffer_load_dwordx4 v[4:7], v14, s[44:47], s100 offen sc1
    s_waitcnt vmcnt(5)
    ds_read_b64_tr_b16 a[96:97], v19 offset:8192
    ds_read_b64_tr_b16 a[98:99], v19 offset:8448
    ds_read_b64_tr_b16 a[208:209], v20 offset:8192
    ds_read_b64_tr_b16 a[210:211], v20 offset:8448
    ds_read_b64_tr_b16 a[100:101], v19 offset:9216
    ds_read_b64_tr_b16 a[102:103], v19 offset:9472
    ds_read_b64_tr_b16 a[212:213], v20 offset:9216
    ds_read_b64_tr_b16 a[214:215], v20 offset:9472
    s_waitcnt vmcnt(1)
    ds_read_b64_tr_b16 a[104:105], v19 offset:12288
    ds_read_b64_tr_b16 a[106:107], v19 offset:12544
    ds_read_b64_tr_b16 a[216:217], v20 offset:12288
    ds_read_b64_tr_b16 a[218:219], v20 offset:12544
    ds_read_b64_tr_b16 a[108:109], v19 offset:13312
    ds_read_b64_tr_b16 a[110:111], v19 offset:13568
    ds_read_b64_tr_b16 a[220:221], v20 offset:13312
    ds_read_b64_tr_b16 a[222:223], v20 offset:13568
    s_waitcnt lgkmcnt(0)
    v_add_u32 v9, 6144, v26
    v_add_u32 v10, 12288, v26
    v_add_u32 v8, 18432, v26
    v_and_b32 v20, 31, v0
    v_bfe_u32 v39, v0, 5, 1
    v_mul_u32_u24 v39, 1792, v39
    v_add_u32 v20, v20, v39
    s_lshl_b32 s72, s87, 7
    s_lshl_b32 s73, s88, 5
    s_add_u32 s72, s72, s73
    v_add_u32 v20, s72, v20
    v_lshlrev_b32 v20, 2, v20
    v_bfe_u32 v39, v0, 5, 1
    v_lshlrev_b32 v39, 4, v39
    v_add_u32 v39, s78, v39
    s_cmp_lg_u32 s88, 0
    s_cbranch_scc1 L_B_done
    s_waitcnt vmcnt(0)
    v_xor_b32 v4, s93, v4
    v_xor_b32 v5, s93, v5
    v_xor_b32 v6, s93, v6
    v_xor_b32 v7, s93, v7
    v_or3_b32 v4, v4, v5, v6
    v_or_b32 v4, v4, v7
    v_cmp_ne_u32 vcc, 0, v4
    s_cbranch_vccz L_B_done
    s_mov_b32 s100, 0x9000
    s_mov_b32 s101, 0
    s_waitcnt vmcnt(0)
L_B_loop:
    buffer_load_dwordx4 v[4:7], v14, s[44:47], s100 offen sc1
    s_waitcnt vmcnt(0)
    v_xor_b32 v4, s93, v4
    v_xor_b32 v5, s93, v5
    v_xor_b32 v6, s93, v6
    v_xor_b32 v7, s93, v7
    v_or3_b32 v4, v4, v5, v6
    v_or_b32 v4, v4, v7
    v_cmp_ne_u32 vcc, 0, v4
    s_add_u32 s101, s101, 1
    s_cmp_gt_u32 s101, 400000
    s_cbranch_scc1 L_B_done
    s_cbranch_vccnz L_B_loop
L_B_done:
    s_barrier
    s_add_u32 m0, s78, 8192
    s_mov_b32 s74, 0x48000
    buffer_load_dword v20, s[44:47], s74 offen sc1 lds
    s_add_u32 m0, s77, 0
    s_add_u32 s72, s76, 0
    buffer_load_dwordx4 v21, s[44:47], s72 offen sc1 lds
    s_add_u32 m0, s77, 4096
    s_add_u32 s72, s76, 131072
    buffer_load_dwordx4 v21, s[44:47], s72 offen sc1 lds
    s_add_u32 m0, s77, 8192
    s_add_u32 s72, s76, 262144
    buffer_load_dwordx4 v21, s[44:47], s72 offen sc1 lds
    s_add_u32 m0, s77, 12288
    s_add_u32 s72, s76, 393216
    buffer_load_dwordx4 v21, s[44:47], s72 offen sc1 lds
    s_add_u32 m0, s77, 16384
    s_add_u32 s72, s76, 524288
    buffer_load_dwordx4 v21, s[44:47], s72 offen sc1 lds
    s_add_u32 m0, s77, 20480
    s_add_u32 s72, s76, 655360
    buffer_load_dwordx4 v21, s[44:47], s72 offen sc1 lds
    s_add_u32 m0, s77, 24576
    s_add_u32 s72, s76, 786432
    buffer_load_dwordx4 v21, s[44:47], s72 offen sc1 lds
    s_add_u32 m0, s77, 28672
    s_add_u32 s72, s76, 917504
    buffer_load_dwordx4 v21, s[44:47], s72 offen sc1 lds
    s_mul_i32 s89, s86, 452
    s_lshl_b32 s72, s87, 3
    s_add_u32 s89, s89, s72
    s_mul_i32 s72, s88, 2
    s_add_u32 s89, s89, s72
    s_lshl_b32 s89, s89, 10
    s_add_u32 s89, s89, 0x700000
    v_and_b32 v1, 63, v0
    v_lshlrev_b32 v1, 4, v1
    v_and_b32 v14, 31, v0
    v_lshlrev_b32 v14, 4, v14
    s_lshl_b32 s72, s86, 11
    s_add_u32 s72, s72, 0x70000
    v_add_u32 v14, s72, v14
    s_waitcnt vmcnt(6)
    s_barrier
    ds_read_b64_tr_b16 v[200:201], v22 offset:0
    ds_read_b64_tr_b16 v[202:203], v22 offset:512
    ds_read_b64_tr_b16 v[204:205], v22 offset:2048
    ds_read_b64_tr_b16 v[206:207], v22 offset:2560
    ds_read_b64_tr_b16 v[208:209], v22 offset:4096
    ds_read_b64_tr_b16 v[210:211], v22 offset:4608
    s_waitcnt lgkmcnt(4)
    v_mfma_f32_32x32x16_bf16 v[72:87], a[0:3], v[200:203], 0
    ds_read_b64_tr_b16 v[212:213], v22 offset:6144
    s_add_u32 m0, s77, 32768
    s_add_u32 s72, s76, 1048576
    buffer_load_dwordx4 v21, s[44:47], s72 offen sc1 lds
    v_mfma_f32_32x32x16_bf16 v[88:103], a[112:115], v[200:203], 0
    ds_read_b64_tr_b16 v[214:215], v22 offset:6656
    s_waitcnt lgkmcnt(4)
    v_mfma_f32_32x32x16_bf16 v[72:87], a[4:7], v[204:207], v[72:87]
    s_waitcnt vmcnt(5)
    s_barrier
    ds_read_b64_tr_b16 v[200:201], v22 offset:8192
    s_add_u32 m0, s77, 36864
    s_add_u32 s72, s76, 1179648
    buffer_load_dwordx4 v21, s[44:47], s72 offen sc1 lds
    v_mfma_f32_32x32x16_bf16 v[88:103], a[116:119], v[204:207], v[88:103]
    ds_read_b64_tr_b16 v[202:203], v22 offset:8704
    s_waitcnt lgkmcnt(4)
    v_mfma_f32_32x32x16_bf16 v[72:87], a[8:11], v[208:211], v[72:87]
    ds_read_b64_tr_b16 v[204:205], v22 offset:10240
    s_add_u32 m0, s77, 40960
    s_add_u32 s72, s76, 1310720
    buffer_load_dwordx4 v21, s[44:47], s72 offen sc1 lds
    v_mfma_f32_32x32x16_bf16 v[88:103], a[120:123], v[208:211], v[88:103]
    ds_read_b64_tr_b16 v[206:207], v22 offset:10752
    s_waitcnt lgkmcnt(4)
    v_mfma_f32_32x32x16_bf16 v[72:87], a[12:15], v[212:215], v[72:87]
    ds_read_b64_tr_b16 v[208:209], v22 offset:12288
    s_add_u32 m0, s77, 45056
    s_add_u32 s72, s76, 1441792
    buffer_load_dwordx4 v21, s[44:47], s72 offen sc1 lds
    v_mfma_f32_32x32x16_bf16 v[88:103], a[124:127], v[212:215], v[88:103]
    ds_read_b64_tr_b16 v[210:211], v22 offset:12800
    s_waitcnt lgkmcnt(4)
    v_mfma_f32_32x32x16_bf16 v[72:87], a[16:19], v[200:203], v[72:87]
    ds_read_b64_tr_b16 v[212:213], v22 offset:14336
    s_add_u32 m0, s77, 49152
    s_add_u32 s72, s76, 1572864
    buffer_load_dwordx4 v21, s[44:47], s72 offen sc1 lds
    v_mfma_f32_32x32x16_bf16 v[88:103], a[128:131], v[200:203], v[88:103]
    ds_read_b64_tr_b16 v[214:215], v22 offset:14848
    s_waitcnt lgkmcnt(4)
    v_mfma_f32_32x32x16_bf16 v[72:87], a[20:23], v[204:207], v[72:87]
    s_waitcnt vmcnt(7)
    s_barrier
    ds_read_b64_tr_b16 v[200:201], v22 offset:16384
    s_add_u32 m0, s77, 53248
    s_add_u32 s72, s76, 1703936
    buffer_load_dwordx4 v21, s[44:47], s72 offen sc1 lds
    v_mfma_f32_32x32x16_bf16 v[88:103], a[132:135], v[204:207], v[88:103]
    ds_read_b64_tr_b16 v[202:203], v22 offset:16896
    s_waitcnt lgkmcnt(4)
    v_mfma_f32_32x32x16_bf16 v[72:87], a[24:27], v[208:211], v[72:87]
    ds_read_b64_tr_b16 v[204:205], v22 offset:18432
    s_add_u32 m0, s77, 57344
    s_add_u32 s72, s76, 128
    buffer_load_dwordx4 v21, s[44:47], s72 offen sc1 lds
    v_mfma_f32_32x32x16_bf16 v[88:103], a[136:139], v[208:211], v[88:103]
    ds_read_b64_tr_b16 v[206:207], v22 offset:18944
    s_waitcnt lgkmcnt(4)
    v_mfma_f32_32x32x16_bf16 v[72:87], a[28:31], v[212:215], v[72:87]
    ds_read_b64_tr_b16 v[208:209], v22 offset:20480
    s_add_u32 m0, s77, 61440
    s_add_u32 s72, s76, 131200
    buffer_load_dwordx4 v21, s[44:47], s72 offen sc1 lds
    v_mfma_f32_32x32x16_bf16 v[88:103], a[140:143], v[212:215], v[88:103]
    ds_read_b64_tr_b16 v[210:211], v22 offset:20992
    s_waitcnt lgkmcnt(4)
    v_mfma_f32_32x32x16_bf16 v[72:87], a[32:35], v[200:203], v[72:87]
    ds_read_b64_tr_b16 v[212:213], v22 offset:22528
    s_add_u32 m0, s77, 65536
    s_add_u32 s72, s76, 262272
    buffer_load_dwordx4 v21, s[44:47], s72 offen sc1 lds
    v_mfma_f32_32x32x16_bf16 v[88:103], a[144:147], v[200:203], v[88:103]
    ds_read_b64_tr_b16 v[214:215], v22 offset:23040
    s_waitcnt lgkmcnt(4)
    v_mfma_f32_32x32x16_bf16 v[72:87], a[36:39], v[204:207], v[72:87]
    s_waitcnt vmcnt(9)
    s_barrier
    ds_read_b64_tr_b16 v[200:201], v22 offset:24576
    s_add_u32 m0, s77, 69632
    s_add_u32 s72, s76, 393344
    buffer_load_dwordx4 v21, s[44:47], s72 offen sc1 lds
    v_mfma_f32_32x32x16_bf16 v[88:103], a[148:151], v[204:207], v[88:103]
    ds_read_b64_tr_b16 v[202:203], v22 offset:25088
    s_waitcnt lgkmcnt(4)
    v_mfma_f32_32x32x16_bf16 v[72:87], a[40:43], v[208:211], v[72:87]
    ds_read_b64_tr_b16 v[204:205], v22 offset:26624
    s_add_u32 m0, s77, 73728
    s_add_u32 s72, s76, 524416
    buffer_load_dwordx4 v21, s[44:47], s72 offen sc1 lds
    ds_read_b128 v[40:43], v39 offset:8192
    ds_read_b128 v[44:47], v39 offset:8224
    v_mfma_f32_32x32x16_bf16 v[88:103], a[152:155], v[208:211], v[88:103]
    ds_read_b64_tr_b16 v[206:207], v22 offset:27136
    ds_read_b128 v[48:51], v39 offset:8320
    ds_read_b128 v[52:55], v39 offset:8352
    ds_read_b128 v[56:59], v39 offset:8256
    ds_read_b128 v[60:63], v39 offset:8288
    s_waitcnt lgkmcnt(10)
    v_mfma_f32_32x32x16_bf16 v[72:87], a[44:47], v[212:215], v[72:87]
    ds_read_b64_tr_b16 v[208:209], v22 offset:28672
    s_add_u32 m0, s77, 77824
    s_add_u32 s72, s76, 655488
    buffer_load_dwordx4 v21, s[44:47], s72 offen sc1 lds
    ds_read_b128 v[64:67], v39 offset:8384
    ds_read_b128 v[68:71], v39 offset:8416
    v_mfma_f32_32x32x16_bf16 v[88:103], a[156:159], v[212:215], v[88:103]
    ds_read_b64_tr_b16 v[210:211], v22 offset:29184
    s_waitcnt lgkmcnt(12)
    v_mfma_f32_32x32x16_bf16 v[72:87], a[48:51], v[200:203], v[72:87]
    ds_read_b64_tr_b16 v[212:213], v22 offset:30720
    s_add_u32 m0, s77, 81920
    s_add_u32 s72, s76, 786560
    buffer_load_dwordx4 v21, s[44:47], s72 offen sc1 lds
    v_mfma_f32_32x32x16_bf16 v[88:103], a[160:163], v[200:203], v[88:103]
    ds_read_b64_tr_b16 v[214:215], v22 offset:31232
    s_waitcnt lgkmcnt(10)
    v_mfma_f32_32x32x16_bf16 v[72:87], a[52:55], v[204:207], v[72:87]
    s_waitcnt vmcnt(11)
    s_barrier
    ds_read_b64_tr_b16 v[200:201], v22 offset:32768
    s_add_u32 m0, s77, 86016
    s_add_u32 s72, s76, 917632
    buffer_load_dwordx4 v21, s[44:47], s72 offen sc1 lds
    v_mfma_f32_32x32x16_bf16 v[88:103], a[164:167], v[204:207], v[88:103]
    ds_read_b64_tr_b16 v[202:203], v22 offset:33280
    s_waitcnt lgkmcnt(4)
    v_mfma_f32_32x32x16_bf16 v[72:87], a[56:59], v[208:211], v[72:87]
    ds_read_b64_tr_b16 v[204:205], v22 offset:34816
    s_add_u32 m0, s77, 90112
    s_add_u32 s72, s76, 1048704
    buffer_load_dwordx4 v21, s[44:47], s72 offen sc1 lds
    v_mfma_f32_32x32x16_bf16 v[88:103], a[168:171], v[208:211], v[88:103]
    ds_read_b64_tr_b16 v[206:207], v22 offset:35328
    s_waitcnt lgkmcnt(4)
    v_mfma_f32_32x32x16_bf16 v[72:87], a[60:63], v[212:215], v[72:87]
    ds_read_b64_tr_b16 v[208:209], v22 offset:36864
    s_add_u32 m0, s77, 94208
    s_add_u32 s72, s76, 1179776
    buffer_load_dwordx4 v21, s[44:47], s72 offen sc1 lds
    v_mfma_f32_32x32x16_bf16 v[88:103], a[172:175], v[212:215], v[88:103]
    ds_read_b64_tr_b16 v[210:211], v22 offset:37376
    s_waitcnt lgkmcnt(4)
    v_mfma_f32_32x32x16_bf16 v[72:87], a[64:67], v[200:203], v[72:87]
    ds_read_b64_tr_b16 v[212:213], v22 offset:38912
    s_add_u32 m0, s77, 98304
    s_add_u32 s72, s76, 1310848
    buffer_load_dwordx4 v21, s[44:47], s72 offen sc1 lds
    v_mfma_f32_32x32x16_bf16 v[88:103], a[176:179], v[200:203], v[88:103]
    ds_read_b64_tr_b16 v[214:215], v22 offset:39424
    s_waitcnt lgkmcnt(4)
    v_mfma_f32_32x32x16_bf16 v[72:87], a[68:71], v[204:207], v[72:87]
    s_waitcnt vmcnt(13)
    s_barrier
    ds_read_b64_tr_b16 v[200:201], v22 offset:40960
    s_add_u32 m0, s77, 102400
    s_add_u32 s72, s76, 1441920
    buffer_load_dwordx4 v21, s[44:47], s72 offen sc1 lds
    v_mfma_f32_32x32x16_bf16 v[88:103], a[180:183], v[204:207], v[88:103]
    ds_read_b64_tr_b16 v[202:203], v22 offset:41472
    s_waitcnt lgkmcnt(4)
    v_mfma_f32_32x32x16_bf16 v[72:87], a[72:75], v[208:211], v[72:87]
    ds_read_b64_tr_b16 v[204:205], v22 offset:43008
    s_add_u32 m0, s77, 106496
    s_add_u32 s72, s76, 1572992
    buffer_load_dwordx4 v21, s[44:47], s72 offen sc1 lds
    v_mfma_f32_32x32x16_bf16 v[88:103], a[184:187], v[208:211], v[88:103]
    ds_read_b64_tr_b16 v[206:207], v22 offset:43520
    s_waitcnt lgkmcnt(4)
    v_mfma_f32_32x32x16_bf16 v[72:87], a[76:79], v[212:215], v[72:87]
    ds_read_b64_tr_b16 v[208:209], v22 offset:45056
    s_add_u32 m0, s77, 110592
    s_add_u32 s72, s76, 1704064
    buffer_load_dwordx4 v21, s[44:47], s72 offen sc1 lds
    v_mfma_f32_32x32x16_bf16 v[88:103], a[188:191], v[212:215], v[88:103]
    ds_read_b64_tr_b16 v[210:211], v22 offset:45568
    s_waitcnt lgkmcnt(4)
    v_mfma_f32_32x32x16_bf16 v[72:87], a[80:83], v[200:203], v[72:87]
    ds_read_b64_tr_b16 v[212:213], v22 offset:47104
    s_add_u32 m0, s78, 0
    s_add_u32 s75, s83, 0
    buffer_load_dwordx4 v26, s[56:59], s75 offen offset:0 lds
    v_mfma_f32_32x32x16_bf16 v[88:103], a[192:195], v[200:203], v[88:103]
    ds_read_b64_tr_b16 v[214:215], v22 offset:47616
    s_waitcnt lgkmcnt(4)
    v_mfma_f32_32x32x16_bf16 v[72:87], a[84:87], v[204:207], v[72:87]
    s_waitcnt vmcnt(15)
    s_barrier
    ds_read_b64_tr_b16 v[200:201], v22 offset:49152
    buffer_load_dwordx4 v9, s[56:59], s75 offen offset:1024 lds
    v_mfma_f32_32x32x16_bf16 v[88:103], a[196:199], v[204:207], v[88:103]
    ds_read_b64_tr_b16 v[202:203], v22 offset:49664
    s_waitcnt lgkmcnt(4)
    v_mfma_f32_32x32x16_bf16 v[72:87], a[88:91], v[208:211], v[72:87]
    ds_read_b64_tr_b16 v[204:205], v22 offset:51200
    buffer_load_dwordx4 v10, s[56:59], s75 offen offset:2048 lds
    v_mfma_f32_32x32x16_bf16 v[88:103], a[200:203], v[208:211], v[88:103]
    ds_read_b64_tr_b16 v[206:207], v22 offset:51712
    s_waitcnt lgkmcnt(4)
    v_mfma_f32_32x32x16_bf16 v[72:87], a[92:95], v[212:215], v[72:87]
    ds_read_b64_tr_b16 v[208:209], v22 offset:53248
    buffer_load_dwordx4 v8, s[56:59], s75 offen offset:3072 lds
    v_mfma_f32_32x32x16_bf16 v[88:103], a[204:207], v[212:215], v[88:103]
    ds_read_b64_tr_b16 v[210:211], v22 offset:53760
    s_waitcnt lgkmcnt(4)
    v_mfma_f32_32x32x16_bf16 v[72:87], a[96:99], v[200:203], v[72:87]
    ds_read_b64_tr_b16 v[212:213], v22 offset:55296
    s_add_u32 m0, s78, 4096
    s_add_u32 s75, s83, 28672
    buffer_load_dwordx4 v26, s[56:59], s75 offen offset:0 lds
    v_mfma_f32_32x32x16_bf16 v[88:103], a[208:211], v[200:203], v[88:103]
    ds_read_b64_tr_b16 v[214:215], v22 offset:55808
    s_waitcnt lgkmcnt(4)
    v_mfma_f32_32x32x16_bf16 v[72:87], a[100:103], v[204:207], v[72:87]
    ds_read_b64_tr_b16 v[200:201], v23 offset:0
    buffer_load_dwordx4 v9, s[56:59], s75 offen offset:1024 lds
    v_mfma_f32_32x32x16_bf16 v[88:103], a[212:215], v[204:207], v[88:103]
    ds_read_b64_tr_b16 v[202:203], v23 offset:512
    s_waitcnt lgkmcnt(4)
    v_mfma_f32_32x32x16_bf16 v[72:87], a[104:107], v[208:211], v[72:87]
    ds_read_b64_tr_b16 v[204:205], v23 offset:2048
    buffer_load_dwordx4 v10, s[56:59], s75 offen offset:2048 lds
    v_mfma_f32_32x32x16_bf16 v[88:103], a[216:219], v[208:211], v[88:103]
    ds_read_b64_tr_b16 v[206:207], v23 offset:2560
    s_waitcnt lgkmcnt(4)
    v_mfma_f32_32x32x16_bf16 v[72:87], a[108:111], v[212:215], v[72:87]
    ds_read_b64_tr_b16 v[208:209], v23 offset:4096
    buffer_load_dwordx4 v8, s[56:59], s75 offen offset:3072 lds
    v_mfma_f32_32x32x16_bf16 v[88:103], a[220:223], v[212:215], v[88:103]
    ds_read_b64_tr_b16 v[210:211], v23 offset:4608
    s_waitcnt lgkmcnt(4)
    v_mfma_f32_32x32x16_bf16 v[104:119], a[0:3], v[200:203], 0
    ds_read_b64_tr_b16 v[212:213], v23 offset:6144
    s_add_u32 m0, s78, 8192
    s_add_u32 s75, s83, 57344
    buffer_load_dwordx4 v26, s[56:59], s75 offen offset:0 lds
    v_mfma_f32_32x32x16_bf16 v[120:135], a[112:115], v[200:203], 0
    ds_read_b64_tr_b16 v[214:215], v23 offset:6656
    s_waitcnt lgkmcnt(4)
    v_mfma_f32_32x32x16_bf16 v[104:119], a[4:7], v[204:207], v[104:119]
    ds_read_b64_tr_b16 v[200:201], v23 offset:8192
    buffer_load_dwordx4 v9, s[56:59], s75 offen offset:1024 lds
    v_mfma_f32_32x32x16_bf16 v[120:135], a[116:119], v[204:207], v[120:135]
    ds_read_b64_tr_b16 v[202:203], v23 offset:8704
    s_waitcnt lgkmcnt(4)
    v_mfma_f32_32x32x16_bf16 v[104:119], a[8:11], v[208:211], v[104:119]
    ds_read_b64_tr_b16 v[204:205], v23 offset:10240
    buffer_load_dwordx4 v10, s[56:59], s75 offen offset:2048 lds
    v_mfma_f32_32x32x16_bf16 v[120:135], a[120:123], v[208:211], v[120:135]
    ds_read_b64_tr_b16 v[206:207], v23 offset:10752
    s_waitcnt lgkmcnt(4)
    v_mfma_f32_32x32x16_bf16 v[104:119], a[12:15], v[212:215], v[104:119]
    ds_read_b64_tr_b16 v[208:209], v23 offset:12288
    buffer_load_dwordx4 v8, s[56:59], s75 offen offset:3072 lds
    v_mfma_f32_32x32x16_bf16 v[120:135], a[124:127], v[212:215], v[120:135]
    ds_read_b64_tr_b16 v[210:211], v23 offset:12800
    s_waitcnt lgkmcnt(4)
    v_mfma_f32_32x32x16_bf16 v[104:119], a[16:19], v[200:203], v[104:119]
    ds_read_b64_tr_b16 v[212:213], v23 offset:14336
    v_mfma_f32_32x32x16_bf16 v[120:135], a[128:131], v[200:203], v[120:135]
    ds_read_b64_tr_b16 v[214:215], v23 offset:14848
    s_waitcnt lgkmcnt(4)
    v_mfma_f32_32x32x16_bf16 v[104:119], a[20:23], v[204:207], v[104:119]
    ds_read_b64_tr_b16 v[200:201], v23 offset:16384
    s_waitcnt vmcnt(8)
    ds_read_b64_tr_b16 a[224:225], v27 offset:0
    ds_read_b64_tr_b16 a[226:227], v27 offset:1024
    ds_read_b64_tr_b16 a[228:229], v28 offset:0
    ds_read_b64_tr_b16 a[230:231], v28 offset:1024
    ds_read_b64_tr_b16 a[232:233], v27 offset:2048
    v_mfma_f32_32x32x16_bf16 v[120:135], a[132:135], v[204:207], v[120:135]
    ds_read_b64_tr_b16 v[202:203], v23 offset:16896
    ds_read_b64_tr_b16 a[234:235], v27 offset:3072
    ds_read_b64_tr_b16 a[236:237], v28 offset:2048
    ds_read_b64_tr_b16 a[238:239], v28 offset:3072
    s_waitcnt lgkmcnt(12)
    v_mfma_f32_32x32x16_bf16 v[104:119], a[24:27], v[208:211], v[104:119]
    ds_read_b64_tr_b16 v[204:205], v23 offset:18432
    v_mfma_f32_32x32x16_bf16 v[120:135], a[136:139], v[208:211], v[120:135]
    ds_read_b64_tr_b16 v[206:207], v23 offset:18944
    s_waitcnt lgkmcnt(12)
    v_mfma_f32_32x32x16_bf16 v[104:119], a[28:31], v[212:215], v[104:119]
    ds_read_b64_tr_b16 v[208:209], v23 offset:20480
    v_mfma_f32_32x32x16_bf16 v[120:135], a[140:143], v[212:215], v[120:135]
    ds_read_b64_tr_b16 v[210:211], v23 offset:20992
    s_waitcnt lgkmcnt(7)
    v_mfma_f32_32x32x16_bf16 v[104:119], a[32:35], v[200:203], v[104:119]
    ds_read_b64_tr_b16 v[212:213], v23 offset:22528
    s_waitcnt vmcnt(4)
    ds_read_b64_tr_b16 a[240:241], v27 offset:4096
    ds_read_b64_tr_b16 a[242:243], v27 offset:5120
    ds_read_b64_tr_b16 a[244:245], v28 offset:4096
    ds_read_b64_tr_b16 a[246:247], v28 offset:5120
    ds_read_b64_tr_b16 a[248:249], v27 offset:6144
    v_mfma_f32_32x32x16_bf16 v[120:135], a[144:147], v[200:203], v[120:135]
    ds_read_b64_tr_b16 v[214:215], v23 offset:23040
    ds_read_b64_tr_b16 a[250:251], v27 offset:7168
    ds_read_b64_tr_b16 a[252:253], v28 offset:6144
    ds_read_b64_tr_b16 a[254:255], v28 offset:7168
    buffer_load_dwordx4 v[232:235], v14, s[44:47], 0 offen offset:0 sc1
    s_waitcnt lgkmcnt(12)
    v_mfma_f32_32x32x16_bf16 v[104:119], a[36:39], v[204:207], v[104:119]
    ds_read_b64_tr_b16 v[200:201], v23 offset:24576
    buffer_load_dwordx4 v[236:239], v14, s[44:47], 0 offen offset:512 sc1
    buffer_load_dwordx4 v[240:243], v14, s[44:47], 0 offen offset:1024 sc1
    buffer_load_dwordx4 v[244:247], v14, s[44:47], 0 offen offset:1536 sc1
    v_mfma_f32_32x32x16_bf16 v[120:135], a[148:151], v[204:207], v[120:135]
    ds_read_b64_tr_b16 v[202:203], v23 offset:25088
    s_waitcnt lgkmcnt(12)
    v_mfma_f32_32x32x16_bf16 v[104:119], a[40:43], v[208:211], v[104:119]
    ds_read_b64_tr_b16 v[204:205], v23 offset:26624
    s_add_u32 m0, s78, 0
    s_add_u32 s75, s83, 86016
    buffer_load_dwordx4 v26, s[56:59], s75 offen offset:0 lds
    v_mfma_f32_32x32x16_bf16 v[120:135], a[152:155], v[208:211], v[120:135]
    ds_read_b64_tr_b16 v[206:207], v23 offset:27136
    s_waitcnt lgkmcnt(7)
    v_mfma_f32_32x32x16_bf16 v[104:119], a[44:47], v[212:215], v[104:119]
    ds_read_b64_tr_b16 v[208:209], v23 offset:28672
    buffer_load_dwordx4 v9, s[56:59], s75 offen offset:1024 lds
    v_mfma_f32_32x32x16_bf16 v[120:135], a[156:159], v[212:215], v[120:135]
    ds_read_b64_tr_b16 v[210:211], v23 offset:29184
    s_waitcnt lgkmcnt(4)
    v_mfma_f32_32x32x16_bf16 v[104:119], a[48:51], v[200:203], v[104:119]
    ds_read_b64_tr_b16 v[212:213], v23 offset:30720
    buffer_load_dwordx4 v10, s[56:59], s75 offen offset:2048 lds
    v_mfma_f32_32x32x16_bf16 v[120:135], a[160:163], v[200:203], v[120:135]
    ds_read_b64_tr_b16 v[214:215], v23 offset:31232
    s_waitcnt lgkmcnt(4)
    v_mfma_f32_32x32x16_bf16 v[104:119], a[52:55], v[204:207], v[104:119]
    ds_read_b64_tr_b16 v[200:201], v23 offset:32768
    buffer_load_dwordx4 v8, s[56:59], s75 offen offset:3072 lds
    s_add_u32 m0, s78, 4096
    s_add_u32 s75, s83, 114688
    buffer_load_dwordx4 v26, s[56:59], s75 offen offset:0 lds
    v_mfma_f32_32x32x16_bf16 v[120:135], a[164:167], v[204:207], v[120:135]
    ds_read_b64_tr_b16 v[202:203], v23 offset:33280
    s_waitcnt lgkmcnt(4)
    v_mfma_f32_32x32x16_bf16 v[104:119], a[56:59], v[208:211], v[104:119]
    ds_read_b64_tr_b16 v[204:205], v23 offset:34816
    buffer_load_dwordx4 v9, s[56:59], s75 offen offset:1024 lds
    v_mfma_f32_32x32x16_bf16 v[120:135], a[168:171], v[208:211], v[120:135]
    ds_read_b64_tr_b16 v[206:207], v23 offset:35328
    s_waitcnt lgkmcnt(4)
    v_mfma_f32_32x32x16_bf16 v[104:119], a[60:63], v[212:215], v[104:119]
    ds_read_b64_tr_b16 v[208:209], v23 offset:36864
    buffer_load_dwordx4 v10, s[56:59], s75 offen offset:2048 lds
    v_mfma_f32_32x32x16_bf16 v[120:135], a[172:175], v[212:215], v[120:135]
    ds_read_b64_tr_b16 v[210:211], v23 offset:37376
    s_waitcnt lgkmcnt(4)
    v_mfma_f32_32x32x16_bf16 v[104:119], a[64:67], v[200:203], v[104:119]
    ds_read_b64_tr_b16 v[212:213], v23 offset:38912
    buffer_load_dwordx4 v8, s[56:59], s75 offen offset:3072 lds
    v_mfma_f32_32x32x16_bf16 v[120:135], a[176:179], v[200:203], v[120:135]
    ds_read_b64_tr_b16 v[214:215], v23 offset:39424
    s_waitcnt lgkmcnt(4)
    v_mfma_f32_32x32x16_bf16 v[104:119], a[68:71], v[204:207], v[104:119]
    ds_read_b64_tr_b16 v[200:201], v23 offset:40960
    v_mfma_f32_32x32x16_bf16 v[120:135], a[180:183], v[204:207], v[120:135]
    ds_read_b64_tr_b16 v[202:203], v23 offset:41472
    s_waitcnt lgkmcnt(4)
    v_mfma_f32_32x32x16_bf16 v[104:119], a[72:75], v[208:211], v[104:119]
    ds_read_b64_tr_b16 v[204:205], v23 offset:43008
    s_waitcnt vmcnt(11)
    v_xor_b32 v216, s93, v235
    s_waitcnt vmcnt(10)
    v_xor_b32 v217, s93, v239
    s_waitcnt vmcnt(9)
    v_xor_b32 v218, s93, v243
    s_waitcnt vmcnt(8)
    v_xor_b32 v219, s93, v247
    v_or3_b32 v216, v216, v217, v218
    v_or_b32 v216, v216, v219
    v_cmp_ne_u32 vcc, 0, v216
    s_mov_b32 s101, 0
    s_cbranch_vccz L_st2_ok
L_st2_spin:
    buffer_load_dwordx4 v[232:235], v14, s[44:47], 0 offen offset:0 sc1
    buffer_load_dwordx4 v[236:239], v14, s[44:47], 0 offen offset:512 sc1
    buffer_load_dwordx4 v[240:243], v14, s[44:47], 0 offen offset:1024 sc1
    buffer_load_dwordx4 v[244:247], v14, s[44:47], 0 offen offset:1536 sc1
    s_waitcnt vmcnt(0)
    v_xor_b32 v216, s93, v235
    v_xor_b32 v217, s93, v239
    v_xor_b32 v218, s93, v243
    v_xor_b32 v219, s93, v247
    v_or3_b32 v216, v216, v217, v218
    v_or_b32 v216, v216, v219
    v_cmp_ne_u32 vcc, 0, v216
    s_add_u32 s101, s101, 1
    s_cmp_gt_u32 s101, 400000
    s_cbranch_scc1 L_st2_ok
    s_cbranch_vccnz L_st2_spin
L_st2_ok:
    v_fma_f32 v216, -v232, v40, v72
    v_fma_f32 v217, -v232, v41, v73
    v_fma_f32 v218, -v232, v42, v74
    v_fma_f32 v219, -v232, v43, v75
    v_fma_f32 v220, -v232, v44, v76
    v_mfma_f32_32x32x16_bf16 v[120:135], a[184:187], v[208:211], v[120:135]
    ds_read_b64_tr_b16 v[206:207], v23 offset:43520
    v_fma_f32 v221, -v232, v45, v77
    v_fma_f32 v222, -v232, v46, v78
    v_fma_f32 v223, -v232, v47, v79
    v_mul_f32 v216, v233, v216
    v_mul_f32 v217, v233, v217
    s_waitcnt lgkmcnt(4)
    v_mfma_f32_32x32x16_bf16 v[104:119], a[76:79], v[212:215], v[104:119]
    ds_read_b64_tr_b16 v[208:209], v23 offset:45056
    v_mul_f32 v218, v233, v218
    v_mul_f32 v219, v233, v219
    v_mul_f32 v220, v233, v220
    v_mul_f32 v221, v233, v221
    v_mfma_f32_32x32x16_bf16 v[120:135], a[188:191], v[212:215], v[120:135]
    ds_read_b64_tr_b16 v[210:211], v23 offset:45568
    v_mul_f32 v222, v233, v222
    v_mul_f32 v223, v233, v223
    v_exp_f32 v216, v216
    v_fma_f32 v224, -v232, v48, v80
    s_waitcnt lgkmcnt(4)
    v_mfma_f32_32x32x16_bf16 v[104:119], a[80:83], v[200:203], v[104:119]
    ds_read_b64_tr_b16 v[212:213], v23 offset:47104
    s_barrier
    v_exp_f32 v217, v217
    v_fma_f32 v225, -v232, v49, v81
    v_mfma_f32_32x32x16_bf16 v[120:135], a[192:195], v[200:203], v[120:135]
    ds_read_b64_tr_b16 v[214:215], v23 offset:47616
    v_exp_f32 v218, v218
    v_fma_f32 v226, -v232, v50, v82
    s_waitcnt lgkmcnt(4)
    v_mfma_f32_32x32x16_bf16 v[104:119], a[84:87], v[204:207], v[104:119]
    ds_read_b64_tr_b16 v[200:201], v23 offset:49152
    v_exp_f32 v219, v219
    v_fma_f32 v227, -v232, v51, v83
    v_exp_f32 v220, v220
    v_mfma_f32_32x32x16_bf16 v[120:135], a[196:199], v[204:207], v[120:135]
    ds_read_b64_tr_b16 v[202:203], v23 offset:49664
    v_fma_f32 v228, -v232, v52, v84
    v_exp_f32 v221, v221
    v_fma_f32 v229, -v232, v53, v85
    s_waitcnt lgkmcnt(4)
    v_mfma_f32_32x32x16_bf16 v[104:119], a[88:91], v[208:211], v[104:119]
    ds_read_b64_tr_b16 v[204:205], v23 offset:51200
    v_exp_f32 v222, v222
    v_fma_f32 v230, -v232, v54, v86
    v_exp_f32 v223, v223
    v_mfma_f32_32x32x16_bf16 v[120:135], a[200:203], v[208:211], v[120:135]
    ds_read_b64_tr_b16 v[206:207], v23 offset:51712
    v_fma_f32 v231, -v232, v55, v87
    v_fma_f32 v216, v216, v234, v234
    v_fma_f32 v217, v217, v234, v234
    v_fma_f32 v218, v218, v234, v234
    v_fma_f32 v219, v219, v234, v234
    s_waitcnt lgkmcnt(4)
    v_mfma_f32_32x32x16_bf16 v[104:119], a[92:95], v[212:215], v[104:119]
    ds_read_b64_tr_b16 v[208:209], v23 offset:53248
    v_fma_f32 v220, v220, v234, v234
    v_fma_f32 v221, v221, v234, v234
    v_fma_f32 v222, v222, v234, v234
    v_fma_f32 v223, v223, v234, v234
    v_mfma_f32_32x32x16_bf16 v[120:135], a[204:207], v[212:215], v[120:135]
    ds_read_b64_tr_b16 v[210:211], v23 offset:53760
    v_rcp_f32 v216, v216
    v_rcp_f32 v217, v217
    s_waitcnt lgkmcnt(4)
    v_mfma_f32_32x32x16_bf16 v[104:119], a[96:99], v[200:203], v[104:119]
    ds_read_b64_tr_b16 v[212:213], v23 offset:55296
    v_rcp_f32 v218, v218
    v_rcp_f32 v219, v219
    v_mfma_f32_32x32x16_bf16 v[120:135], a[208:211], v[200:203], v[120:135]
    ds_read_b64_tr_b16 v[214:215], v23 offset:55808
    v_rcp_f32 v220, v220
    v_rcp_f32 v221, v221
    s_waitcnt lgkmcnt(4)
    v_mfma_f32_32x32x16_bf16 v[104:119], a[100:103], v[204:207], v[104:119]
    ds_read_b64_tr_b16 v[200:201], v24 offset:0
    v_rcp_f32 v222, v222
    v_rcp_f32 v223, v223
    v_mul_f32 v224, v216, v224
    v_mfma_f32_32x32x16_bf16 v[120:135], a[212:215], v[204:207], v[120:135]
    ds_read_b64_tr_b16 v[202:203], v24 offset:512
    v_mul_f32 v225, v217, v225
    v_mul_f32 v226, v218, v226
    v_mul_f32 v227, v219, v227
    v_mul_f32 v228, v220, v228
    v_mul_f32 v229, v221, v229
    s_waitcnt lgkmcnt(4)
    v_mfma_f32_32x32x16_bf16 v[104:119], a[104:107], v[208:211], v[104:119]
    ds_read_b64_tr_b16 v[204:205], v24 offset:2048
    v_mul_f32 v230, v222, v230
    v_mul_f32 v231, v223, v231
    v_cvt_pk_bf16_f32 v16, v224, v225
    v_cvt_pk_bf16_f32 v17, v226, v227
    v_mfma_f32_32x32x16_bf16 v[120:135], a[216:219], v[208:211], v[120:135]
    ds_read_b64_tr_b16 v[206:207], v24 offset:2560
    v_cvt_pk_bf16_f32 v18, v228, v229
    v_cvt_pk_bf16_f32 v19, v230, v231
    s_add_u32 s73, s89, 0
    buffer_store_dwordx4 v[16:19], v1, s[44:47], s73 offen sc1
    s_waitcnt lgkmcnt(4)
    v_mfma_f32_32x32x16_bf16 v[104:119], a[108:111], v[212:215], v[104:119]
    ds_read_b64_tr_b16 v[208:209], v24 offset:4096
    v_fma_f32 v216, -v232, v56, v88
    v_fma_f32 v217, -v232, v57, v89
    v_fma_f32 v218, -v232, v58, v90
    v_fma_f32 v219, -v232, v59, v91
    v_fma_f32 v220, -v232, v60, v92
    v_mfma_f32_32x32x16_bf16 v[120:135], a[220:223], v[212:215], v[120:135]
    ds_read_b64_tr_b16 v[210:211], v24 offset:4608
    v_fma_f32 v221, -v232, v61, v93
    v_fma_f32 v222, -v232, v62, v94
    v_fma_f32 v223, -v232, v63, v95
    v_mul_f32 v216, v233, v216
    s_waitcnt lgkmcnt(4)
    v_mfma_f32_32x32x16_bf16 v[136:151], a[0:3], v[200:203], 0
    ds_read_b64_tr_b16 v[212:213], v24 offset:6144
    v_mul_f32 v217, v233, v217
    v_mul_f32 v218, v233, v218
    v_mul_f32 v219, v233, v219
    v_mul_f32 v220, v233, v220
    v_mul_f32 v221, v233, v221
    v_mfma_f32_32x32x16_bf16 v[152:167], a[112:115], v[200:203], 0
    ds_read_b64_tr_b16 v[214:215], v24 offset:6656
    v_mul_f32 v222, v233, v222
    v_mul_f32 v223, v233, v223
    v_exp_f32 v216, v216
    s_waitcnt lgkmcnt(4)
    v_mfma_f32_32x32x16_bf16 v[136:151], a[4:7], v[204:207], v[136:151]
    ds_read_b64_tr_b16 v[200:201], v24 offset:8192
    v_fma_f32 v224, -v232, v64, v96
    v_exp_f32 v217, v217
    v_fma_f32 v225, -v232, v65, v97
    v_mfma_f32_32x32x16_bf16 v[152:167], a[116:119], v[204:207], v[152:167]
    ds_read_b64_tr_b16 v[202:203], v24 offset:8704
    v_exp_f32 v218, v218
    v_fma_f32 v226, -v232, v66, v98
    v_exp_f32 v219, v219
    s_waitcnt lgkmcnt(4)
    v_mfma_f32_32x32x16_bf16 v[136:151], a[8:11], v[208:211], v[136:151]
    ds_read_b64_tr_b16 v[204:205], v24 offset:10240
    v_fma_f32 v227, -v232, v67, v99
    v_exp_f32 v220, v220
    v_fma_f32 v228, -v232, v68, v100
    v_mfma_f32_32x32x16_bf16 v[152:167], a[120:123], v[208:211], v[152:167]
    ds_read_b64_tr_b16 v[206:207], v24 offset:10752
    v_exp_f32 v221, v221
    v_fma_f32 v229, -v232, v69, v101
    v_exp_f32 v222, v222
    s_waitcnt lgkmcnt(4)
    v_mfma_f32_32x32x16_bf16 v[136:151], a[12:15], v[212:215], v[136:151]
    ds_read_b64_tr_b16 v[208:209], v24 offset:12288
    s_barrier
    s_add_u32 m0, s79, 0
    s_add_u32 s75, s83, 143360
    buffer_load_dwordx4 v26, s[56:59], s75 offen offset:0 lds
    v_fma_f32 v230, -v232, v70, v102
    v_mfma_f32_32x32x16_bf16 v[152:167], a[124:127], v[212:215], v[152:167]
    ds_read_b64_tr_b16 v[210:211], v24 offset:12800
    v_exp_f32 v223, v223
    v_fma_f32 v231, -v232, v71, v103
    v_fma_f32 v216, v216, v234, v234
    s_waitcnt lgkmcnt(4)
    v_mfma_f32_32x32x16_bf16 v[136:151], a[16:19], v[200:203], v[136:151]
    ds_read_b64_tr_b16 v[212:213], v24 offset:14336
    v_fma_f32 v217, v217, v234, v234
    v_fma_f32 v218, v218, v234, v234
    v_fma_f32 v219, v219, v234, v234
    v_fma_f32 v220, v220, v234, v234
    v_fma_f32 v221, v221, v234, v234
    v_mfma_f32_32x32x16_bf16 v[152:167], a[128:131], v[200:203], v[152:167]
    ds_read_b64_tr_b16 v[214:215], v24 offset:14848
    v_fma_f32 v222, v222, v234, v234
    v_fma_f32 v223, v223, v234, v234
    v_rcp_f32 v216, v216
    s_waitcnt lgkmcnt(4)
    v_mfma_f32_32x32x16_bf16 v[136:151], a[20:23], v[204:207], v[136:151]
    ds_read_b64_tr_b16 v[200:201], v24 offset:16384
    buffer_load_dwordx4 v9, s[56:59], s75 offen offset:1024 lds
    v_rcp_f32 v217, v217
    v_mfma_f32_32x32x16_bf16 v[152:167], a[132:135], v[204:207], v[152:167]
    ds_read_b64_tr_b16 v[202:203], v24 offset:16896
    v_rcp_f32 v218, v218
    v_rcp_f32 v219, v219
    s_waitcnt lgkmcnt(4)
    v_mfma_f32_32x32x16_bf16 v[136:151], a[24:27], v[208:211], v[136:151]
    ds_read_b64_tr_b16 v[204:205], v24 offset:18432
    v_rcp_f32 v220, v220
    v_rcp_f32 v221, v221
    v_mfma_f32_32x32x16_bf16 v[152:167], a[136:139], v[208:211], v[152:167]
    ds_read_b64_tr_b16 v[206:207], v24 offset:18944
    v_rcp_f32 v222, v222
    v_rcp_f32 v223, v223
    v_mul_f32 v224, v216, v224
    s_waitcnt lgkmcnt(4)
    v_mfma_f32_32x32x16_bf16 v[136:151], a[28:31], v[212:215], v[136:151]
    ds_read_b64_tr_b16 v[208:209], v24 offset:20480
    buffer_load_dwordx4 v10, s[56:59], s75 offen offset:2048 lds
    v_mul_f32 v225, v217, v225
    v_mul_f32 v226, v218, v226
    v_mul_f32 v227, v219, v227
    v_mfma_f32_32x32x16_bf16 v[152:167], a[140:143], v[212:215], v[152:167]
    ds_read_b64_tr_b16 v[210:211], v24 offset:20992
    v_mul_f32 v228, v220, v228
    v_mul_f32 v229, v221, v229
    v_mul_f32 v230, v222, v230
    v_mul_f32 v231, v223, v231
    v_cvt_pk_bf16_f32 v16, v224, v225
    s_waitcnt lgkmcnt(4)
    v_mfma_f32_32x32x16_bf16 v[136:151], a[32:35], v[200:203], v[136:151]
    ds_read_b64_tr_b16 v[212:213], v24 offset:22528
    v_cvt_pk_bf16_f32 v17, v226, v227
    v_cvt_pk_bf16_f32 v18, v228, v229
    v_cvt_pk_bf16_f32 v19, v230, v231
    s_add_u32 s73, s89, 1024
    v_mfma_f32_32x32x16_bf16 v[152:167], a[144:147], v[200:203], v[152:167]
    ds_read_b64_tr_b16 v[214:215], v24 offset:23040
    buffer_store_dwordx4 v[16:19], v1, s[44:47], s73 offen sc1
    v_fma_f32 v216, -v236, v40, v104
    v_fma_f32 v217, -v236, v41, v105
    v_fma_f32 v218, -v236, v42, v106
    s_waitcnt lgkmcnt(4)
    v_mfma_f32_32x32x16_bf16 v[136:151], a[36:39], v[204:207], v[136:151]
    ds_read_b64_tr_b16 v[200:201], v24 offset:24576
    buffer_load_dwordx4 v8, s[56:59], s75 offen offset:3072 lds
    v_fma_f32 v219, -v236, v43, v107
    v_fma_f32 v220, -v236, v44, v108
    v_fma_f32 v221, -v236, v45, v109
    v_mfma_f32_32x32x16_bf16 v[152:167], a[148:151], v[204:207], v[152:167]
    ds_read_b64_tr_b16 v[202:203], v24 offset:25088
    v_fma_f32 v222, -v236, v46, v110
    v_fma_f32 v223, -v236, v47, v111
    v_mul_f32 v216, v237, v216
    v_mul_f32 v217, v237, v217
    v_mul_f32 v218, v237, v218
    s_waitcnt lgkmcnt(4)
    v_mfma_f32_32x32x16_bf16 v[136:151], a[40:43], v[208:211], v[136:151]
    ds_read_b64_tr_b16 v[204:205], v24 offset:26624
    v_mul_f32 v219, v237, v219
    v_mul_f32 v220, v237, v220
    v_mul_f32 v221, v237, v221
    v_mul_f32 v222, v237, v222
    v_mfma_f32_32x32x16_bf16 v[152:167], a[152:155], v[208:211], v[152:167]
    ds_read_b64_tr_b16 v[206:207], v24 offset:27136
    v_mul_f32 v223, v237, v223
    v_exp_f32 v216, v216
    v_fma_f32 v224, -v236, v48, v112
    s_waitcnt lgkmcnt(4)
    v_mfma_f32_32x32x16_bf16 v[136:151], a[44:47], v[212:215], v[136:151]
    ds_read_b64_tr_b16 v[208:209], v24 offset:28672
    s_add_u32 m0, s17, 0
    s_add_u32 s72, s31, 0
    buffer_load_dwordx4 v33, s[44:47], s72 offen sc1 lds
    v_exp_f32 v217, v217
    v_mfma_f32_32x32x16_bf16 v[152:167], a[156:159], v[212:215], v[152:167]
    ds_read_b64_tr_b16 v[210:211], v24 offset:29184
    s_add_u32 m0, s17, 4096
    s_add_u32 s72, s31, 128
    buffer_load_dwordx4 v33, s[44:47], s72 offen sc1 lds
    v_fma_f32 v225, -v236, v49, v113
    s_waitcnt lgkmcnt(4)
    v_mfma_f32_32x32x16_bf16 v[136:151], a[48:51], v[200:203], v[136:151]
    ds_read_b64_tr_b16 v[212:213], v24 offset:30720
    s_add_u32 m0, s79, 4096
    s_add_u32 s75, s83, 172032
    buffer_load_dwordx4 v26, s[56:59], s75 offen offset:0 lds
    v_exp_f32 v218, v218
    v_mfma_f32_32x32x16_bf16 v[152:167], a[160:163], v[200:203], v[152:167]
    ds_read_b64_tr_b16 v[214:215], v24 offset:31232
    v_fma_f32 v226, -v236, v50, v114
    v_exp_f32 v219, v219
    v_fma_f32 v227, -v236, v51, v115
    s_waitcnt lgkmcnt(4)
    v_mfma_f32_32x32x16_bf16 v[136:151], a[52:55], v[204:207], v[136:151]
    ds_read_b64_tr_b16 v[200:201], v24 offset:32768
    buffer_load_dwordx4 v9, s[56:59], s75 offen offset:1024 lds
    v_exp_f32 v220, v220
    v_fma_f32 v228, -v236, v52, v116
    v_mfma_f32_32x32x16_bf16 v[152:167], a[164:167], v[204:207], v[152:167]
    ds_read_b64_tr_b16 v[202:203], v24 offset:33280
    v_exp_f32 v221, v221
    v_fma_f32 v229, -v236, v53, v117
    v_exp_f32 v222, v222
    s_waitcnt lgkmcnt(4)
    v_mfma_f32_32x32x16_bf16 v[136:151], a[56:59], v[208:211], v[136:151]
    ds_read_b64_tr_b16 v[204:205], v24 offset:34816
    v_fma_f32 v230, -v236, v54, v118
    v_exp_f32 v223, v223
    v_fma_f32 v231, -v236, v55, v119
    v_fma_f32 v216, v216, v238, v238
    v_mfma_f32_32x32x16_bf16 v[152:167], a[168:171], v[208:211], v[152:167]
    ds_read_b64_tr_b16 v[206:207], v24 offset:35328
    v_fma_f32 v217, v217, v238, v238
    v_fma_f32 v218, v218, v238, v238
    v_fma_f32 v219, v219, v238, v238
    v_fma_f32 v220, v220, v238, v238
    s_waitcnt lgkmcnt(4)
    v_mfma_f32_32x32x16_bf16 v[136:151], a[60:63], v[212:215], v[136:151]
    ds_read_b64_tr_b16 v[208:209], v24 offset:36864
    buffer_load_dwordx4 v10, s[56:59], s75 offen offset:2048 lds
    v_fma_f32 v221, v221, v238, v238
    v_fma_f32 v222, v222, v238, v238
    v_fma_f32 v223, v223, v238, v238
    v_mfma_f32_32x32x16_bf16 v[152:167], a[172:175], v[212:215], v[152:167]
    ds_read_b64_tr_b16 v[210:211], v24 offset:37376
    v_rcp_f32 v216, v216
    v_rcp_f32 v217, v217
    s_waitcnt lgkmcnt(4)
    v_mfma_f32_32x32x16_bf16 v[136:151], a[64:67], v[200:203], v[136:151]
    ds_read_b64_tr_b16 v[212:213], v24 offset:38912
    v_rcp_f32 v218, v218
    v_rcp_f32 v219, v219
    v_mfma_f32_32x32x16_bf16 v[152:167], a[176:179], v[200:203], v[152:167]
    ds_read_b64_tr_b16 v[214:215], v24 offset:39424
    v_rcp_f32 v220, v220
    v_rcp_f32 v221, v221
    s_waitcnt lgkmcnt(4)
    v_mfma_f32_32x32x16_bf16 v[136:151], a[68:71], v[204:207], v[136:151]
    ds_read_b64_tr_b16 v[200:201], v24 offset:40960
    buffer_load_dwordx4 v8, s[56:59], s75 offen offset:3072 lds
    v_rcp_f32 v222, v222
    v_rcp_f32 v223, v223
    v_mfma_f32_32x32x16_bf16 v[152:167], a[180:183], v[204:207], v[152:167]
    ds_read_b64_tr_b16 v[202:203], v24 offset:41472
    v_mul_f32 v224, v216, v224
    v_mul_f32 v225, v217, v225
    v_mul_f32 v226, v218, v226
    v_mul_f32 v227, v219, v227
    s_waitcnt lgkmcnt(4)
    v_mfma_f32_32x32x16_bf16 v[136:151], a[72:75], v[208:211], v[136:151]
    ds_read_b64_tr_b16 v[204:205], v24 offset:43008
    v_mul_f32 v228, v220, v228
    v_mul_f32 v229, v221, v229
    v_mul_f32 v230, v222, v230
    v_mul_f32 v231, v223, v231
    v_cvt_pk_bf16_f32 v16, v224, v225
    v_mfma_f32_32x32x16_bf16 v[152:167], a[184:187], v[208:211], v[152:167]
    ds_read_b64_tr_b16 v[206:207], v24 offset:43520
    v_cvt_pk_bf16_f32 v17, v226, v227
    v_cvt_pk_bf16_f32 v18, v228, v229
    v_cvt_pk_bf16_f32 v19, v230, v231
    s_add_u32 s73, s89, 115712
    s_waitcnt lgkmcnt(4)
    v_mfma_f32_32x32x16_bf16 v[136:151], a[76:79], v[212:215], v[136:151]
    ds_read_b64_tr_b16 v[208:209], v24 offset:45056
    s_add_u32 m0, s79, 8192
    s_add_u32 s75, s83, 200704
    buffer_load_dwordx4 v26, s[56:59], s75 offen offset:0 lds
    buffer_store_dwordx4 v[16:19], v1, s[44:47], s73 offen sc1
    v_mfma_f32_32x32x16_bf16 v[152:167], a[188:191], v[212:215], v[152:167]
    ds_read_b64_tr_b16 v[210:211], v24 offset:45568
    v_fma_f32 v216, -v236, v56, v120
    v_fma_f32 v217, -v236, v57, v121
    v_fma_f32 v218, -v236, v58, v122
    v_fma_f32 v219, -v236, v59, v123
    v_fma_f32 v220, -v236, v60, v124
    s_waitcnt lgkmcnt(4)
    v_mfma_f32_32x32x16_bf16 v[136:151], a[80:83], v[200:203], v[136:151]
    ds_read_b64_tr_b16 v[212:213], v24 offset:47104
    v_fma_f32 v221, -v236, v61, v125
    v_fma_f32 v222, -v236, v62, v126
    v_fma_f32 v223, -v236, v63, v127
    v_mul_f32 v216, v237, v216
    v_mfma_f32_32x32x16_bf16 v[152:167], a[192:195], v[200:203], v[152:167]
    ds_read_b64_tr_b16 v[214:215], v24 offset:47616
    v_mul_f32 v217, v237, v217
    v_mul_f32 v218, v237, v218
    v_mul_f32 v219, v237, v219
    v_mul_f32 v220, v237, v220
    v_mul_f32 v221, v237, v221
    s_waitcnt lgkmcnt(4)
    v_mfma_f32_32x32x16_bf16 v[136:151], a[84:87], v[204:207], v[136:151]
    ds_read_b64_tr_b16 v[200:201], v24 offset:49152
    buffer_load_dwordx4 v9, s[56:59], s75 offen offset:1024 lds
    v_mul_f32 v222, v237, v222
    v_mul_f32 v223, v237, v223
    v_mfma_f32_32x32x16_bf16 v[152:167], a[196:199], v[204:207], v[152:167]
    ds_read_b64_tr_b16 v[202:203], v24 offset:49664
    v_exp_f32 v216, v216
    v_fma_f32 v224, -v236, v64, v128
    v_exp_f32 v217, v217
    s_waitcnt lgkmcnt(4)
    v_mfma_f32_32x32x16_bf16 v[136:151], a[88:91], v[208:211], v[136:151]
    ds_read_b64_tr_b16 v[204:205], v24 offset:51200
    v_fma_f32 v225, -v236, v65, v129
    v_exp_f32 v218, v218
    v_fma_f32 v226, -v236, v66, v130
    v_mfma_f32_32x32x16_bf16 v[152:167], a[200:203], v[208:211], v[152:167]
    ds_read_b64_tr_b16 v[206:207], v24 offset:51712
    v_exp_f32 v219, v219
    v_fma_f32 v227, -v236, v67, v131
    v_exp_f32 v220, v220
    s_waitcnt lgkmcnt(4)
    v_mfma_f32_32x32x16_bf16 v[136:151], a[92:95], v[212:215], v[136:151]
    ds_read_b64_tr_b16 v[208:209], v24 offset:53248
    buffer_load_dwordx4 v10, s[56:59], s75 offen offset:2048 lds
    v_fma_f32 v228, -v236, v68, v132
    v_exp_f32 v221, v221
    v_mfma_f32_32x32x16_bf16 v[152:167], a[204:207], v[212:215], v[152:167]
    ds_read_b64_tr_b16 v[210:211], v24 offset:53760
    v_fma_f32 v229, -v236, v69, v133
    v_exp_f32 v222, v222
    v_fma_f32 v230, -v236, v70, v134
    s_waitcnt lgkmcnt(4)
    v_mfma_f32_32x32x16_bf16 v[136:151], a[96:99], v[200:203], v[136:151]
    ds_read_b64_tr_b16 v[212:213], v24 offset:55296
    v_exp_f32 v223, v223
    v_fma_f32 v231, -v236, v71, v135
    v_fma_f32 v216, v216, v238, v238
    v_fma_f32 v217, v217, v238, v238
    v_mfma_f32_32x32x16_bf16 v[152:167], a[208:211], v[200:203], v[152:167]
    ds_read_b64_tr_b16 v[214:215], v24 offset:55808
    v_fma_f32 v218, v218, v238, v238
    v_fma_f32 v219, v219, v238, v238
    v_fma_f32 v220, v220, v238, v238
    v_fma_f32 v221, v221, v238, v238
    v_fma_f32 v222, v222, v238, v238
    s_waitcnt lgkmcnt(4)
    v_mfma_f32_32x32x16_bf16 v[136:151], a[100:103], v[204:207], v[136:151]
    ds_read_b64_tr_b16 v[200:201], v25 offset:0
    buffer_load_dwordx4 v8, s[56:59], s75 offen offset:3072 lds
    v_fma_f32 v223, v223, v238, v238
    v_rcp_f32 v216, v216
    v_mfma_f32_32x32x16_bf16 v[152:167], a[212:215], v[204:207], v[152:167]
    ds_read_b64_tr_b16 v[202:203], v25 offset:512
    v_rcp_f32 v217, v217
    v_rcp_f32 v218, v218
    s_waitcnt lgkmcnt(4)
    v_mfma_f32_32x32x16_bf16 v[136:151], a[104:107], v[208:211], v[136:151]
    ds_read_b64_tr_b16 v[204:205], v25 offset:2048
    v_rcp_f32 v219, v219
    v_rcp_f32 v220, v220
    v_mfma_f32_32x32x16_bf16 v[152:167], a[216:219], v[208:211], v[152:167]
    ds_read_b64_tr_b16 v[206:207], v25 offset:2560
    v_rcp_f32 v221, v221
    v_rcp_f32 v222, v222
    s_waitcnt lgkmcnt(4)
    v_mfma_f32_32x32x16_bf16 v[136:151], a[108:111], v[212:215], v[136:151]
    ds_read_b64_tr_b16 v[208:209], v25 offset:4096
    v_rcp_f32 v223, v223
    v_mul_f32 v224, v216, v224
    v_mul_f32 v225, v217, v225
    v_mul_f32 v226, v218, v226
    v_mfma_f32_32x32x16_bf16 v[152:167], a[220:223], v[212:215], v[152:167]
    ds_read_b64_tr_b16 v[210:211], v25 offset:4608
    v_mul_f32 v227, v219, v227
    v_mul_f32 v228, v220, v228
    v_mul_f32 v229, v221, v229
    v_mul_f32 v230, v222, v230
    v_mul_f32 v231, v223, v231
    s_waitcnt lgkmcnt(4)
    v_mfma_f32_32x32x16_bf16 v[168:183], a[0:3], v[200:203], 0
    ds_read_b64_tr_b16 v[212:213], v25 offset:6144
    v_cvt_pk_bf16_f32 v16, v224, v225
    v_cvt_pk_bf16_f32 v17, v226, v227
    v_cvt_pk_bf16_f32 v18, v228, v229
    v_cvt_pk_bf16_f32 v19, v230, v231
    s_add_u32 s73, s89, 116736
    v_mfma_f32_32x32x16_bf16 v[184:199], a[112:115], v[200:203], 0
    ds_read_b64_tr_b16 v[214:215], v25 offset:6656
    buffer_store_dwordx4 v[16:19], v1, s[44:47], s73 offen sc1
    s_waitcnt lgkmcnt(4)
    v_mfma_f32_32x32x16_bf16 v[168:183], a[4:7], v[204:207], v[168:183]
    ds_read_b64_tr_b16 v[200:201], v25 offset:8192
    v_mfma_f32_32x32x16_bf16 v[184:199], a[116:119], v[204:207], v[184:199]
    ds_read_b64_tr_b16 v[202:203], v25 offset:8704
    s_waitcnt lgkmcnt(4)
    v_mfma_f32_32x32x16_bf16 v[168:183], a[8:11], v[208:211], v[168:183]
    ds_read_b64_tr_b16 v[204:205], v25 offset:10240
    ds_read_b64_tr_b16 a[0:1], v27 offset:8192
    ds_read_b64_tr_b16 a[2:3], v27 offset:9216
    ds_read_b64_tr_b16 a[112:113], v28 offset:8192
    ds_read_b64_tr_b16 a[114:115], v28 offset:9216
    ds_read_b64_tr_b16 a[4:5], v27 offset:10240
    ds_read_b64_tr_b16 a[6:7], v27 offset:11264
    v_mfma_f32_32x32x16_bf16 v[184:199], a[120:123], v[208:211], v[184:199]
    ds_read_b64_tr_b16 v[206:207], v25 offset:10752
    ds_read_b64_tr_b16 a[116:117], v28 offset:10240
    ds_read_b64_tr_b16 a[118:119], v28 offset:11264
    v_fma_f32 v216, -v240, v40, v136
    v_fma_f32 v217, -v240, v41, v137
    v_fma_f32 v218, -v240, v42, v138
    s_waitcnt lgkmcnt(12)
    v_mfma_f32_32x32x16_bf16 v[168:183], a[12:15], v[212:215], v[168:183]
    ds_read_b64_tr_b16 v[208:209], v25 offset:12288
    v_fma_f32 v219, -v240, v43, v139
    v_fma_f32 v220, -v240, v44, v140
    v_fma_f32 v221, -v240, v45, v141
    v_fma_f32 v222, -v240, v46, v142
    v_fma_f32 v223, -v240, v47, v143
    v_mul_f32 v216, v241, v216
    v_mfma_f32_32x32x16_bf16 v[184:199], a[124:127], v[212:215], v[184:199]
    ds_read_b64_tr_b16 v[210:211], v25 offset:12800
    v_mul_f32 v217, v241, v217
    v_mul_f32 v218, v241, v218
    v_mul_f32 v219, v241, v219
    v_mul_f32 v220, v241, v220
    v_mul_f32 v221, v241, v221
    s_waitcnt lgkmcnt(12)
    v_mfma_f32_32x32x16_bf16 v[168:183], a[16:19], v[200:203], v[168:183]
    ds_read_b64_tr_b16 v[212:213], v25 offset:14336
    s_waitcnt vmcnt(22)
    ds_read_b64_tr_b16 a[8:9], v27 offset:0
    ds_read_b64_tr_b16 a[10:11], v27 offset:1024
    ds_read_b64_tr_b16 a[120:121], v28 offset:0
    ds_read_b64_tr_b16 a[122:123], v28 offset:1024
    ds_read_b64_tr_b16 a[12:13], v27 offset:2048
    ds_read_b64_tr_b16 a[14:15], v27 offset:3072
    v_mfma_f32_32x32x16_bf16 v[184:199], a[128:131], v[200:203], v[184:199]
    ds_read_b64_tr_b16 v[214:215], v25 offset:14848
    ds_read_b64_tr_b16 a[124:125], v28 offset:2048
    ds_read_b64_tr_b16 a[126:127], v28 offset:3072
    v_mul_f32 v222, v241, v222
    v_mul_f32 v223, v241, v223
    s_waitcnt lgkmcnt(14)
    v_mfma_f32_32x32x16_bf16 v[168:183], a[20:23], v[204:207], v[168:183]
    ds_read_b64_tr_b16 v[200:201], v25 offset:16384
    s_waitcnt lgkmcnt(13)
    s_add_u32 m0, s78, 8192
    s_add_u32 s75, s83, 229376
    buffer_load_dwordx4 v26, s[56:59], s75 offen offset:0 lds
    v_exp_f32 v216, v216
    v_fma_f32 v224, -v240, v48, v144
    v_mfma_f32_32x32x16_bf16 v[184:199], a[132:135], v[204:207], v[184:199]
    ds_read_b64_tr_b16 v[202:203], v25 offset:16896
    buffer_load_dwordx4 v9, s[56:59], s75 offen offset:1024 lds
    v_exp_f32 v217, v217
    v_fma_f32 v225, -v240, v49, v145
    s_waitcnt lgkmcnt(12)
    v_mfma_f32_32x32x16_bf16 v[168:183], a[24:27], v[208:211], v[168:183]
    ds_read_b64_tr_b16 v[204:205], v25 offset:18432
    s_waitcnt vmcnt(20)
    ds_read_b64_tr_b16 a[16:17], v27 offset:4096
    ds_read_b64_tr_b16 a[18:19], v27 offset:5120
    ds_read_b64_tr_b16 a[128:129], v28 offset:4096
    ds_read_b64_tr_b16 a[130:131], v28 offset:5120
    ds_read_b64_tr_b16 a[20:21], v27 offset:6144
    ds_read_b64_tr_b16 a[22:23], v27 offset:7168
    v_mfma_f32_32x32x16_bf16 v[184:199], a[136:139], v[208:211], v[184:199]
    ds_read_b64_tr_b16 v[206:207], v25 offset:18944
    ds_read_b64_tr_b16 a[132:133], v28 offset:6144
    ds_read_b64_tr_b16 a[134:135], v28 offset:7168
    buffer_load_dwordx4 v10, s[56:59], s75 offen offset:2048 lds
    buffer_load_dwordx4 v8, s[56:59], s75 offen offset:3072 lds
    s_waitcnt lgkmcnt(14)
    v_mfma_f32_32x32x16_bf16 v[168:183], a[28:31], v[212:215], v[168:183]
    ds_read_b64_tr_b16 v[208:209], v25 offset:20480
    v_exp_f32 v218, v218
    v_fma_f32 v226, -v240, v50, v146
    v_exp_f32 v219, v219
    v_fma_f32 v227, -v240, v51, v147
    v_mfma_f32_32x32x16_bf16 v[184:199], a[140:143], v[212:215], v[184:199]
    ds_read_b64_tr_b16 v[210:211], v25 offset:20992
    v_exp_f32 v220, v220
    v_fma_f32 v228, -v240, v52, v148
    v_exp_f32 v221, v221
    s_waitcnt lgkmcnt(12)
    v_mfma_f32_32x32x16_bf16 v[168:183], a[32:35], v[200:203], v[168:183]
    ds_read_b64_tr_b16 v[212:213], v25 offset:22528
    s_waitcnt vmcnt(16)
    ds_read_b64_tr_b16 a[24:25], v29 offset:0
    ds_read_b64_tr_b16 a[26:27], v29 offset:1024
    ds_read_b64_tr_b16 a[136:137], v30 offset:0
    ds_read_b64_tr_b16 a[138:139], v30 offset:1024
    ds_read_b64_tr_b16 a[28:29], v29 offset:2048
    ds_read_b64_tr_b16 a[30:31], v29 offset:3072
    v_mfma_f32_32x32x16_bf16 v[184:199], a[144:147], v[200:203], v[184:199]
    ds_read_b64_tr_b16 v[214:215], v25 offset:23040
    ds_read_b64_tr_b16 a[140:141], v30 offset:2048
    ds_read_b64_tr_b16 a[142:143], v30 offset:3072
    s_add_u32 m0, s78, 0
    s_add_u32 s75, s83, 258048
    buffer_load_dwordx4 v26, s[56:59], s75 offen offset:0 lds
    s_waitcnt lgkmcnt(14)
    v_mfma_f32_32x32x16_bf16 v[168:183], a[36:39], v[204:207], v[168:183]
    ds_read_b64_tr_b16 v[200:201], v25 offset:24576
    buffer_load_dwordx4 v9, s[56:59], s75 offen offset:1024 lds
    buffer_load_dwordx4 v10, s[56:59], s75 offen offset:2048 lds
    v_fma_f32 v229, -v240, v53, v149
    v_mfma_f32_32x32x16_bf16 v[184:199], a[148:151], v[204:207], v[184:199]
    ds_read_b64_tr_b16 v[202:203], v25 offset:25088
    buffer_load_dwordx4 v8, s[56:59], s75 offen offset:3072 lds
    v_exp_f32 v222, v222
    v_fma_f32 v230, -v240, v54, v150
    v_exp_f32 v223, v223
    s_waitcnt lgkmcnt(12)
    v_mfma_f32_32x32x16_bf16 v[168:183], a[40:43], v[208:211], v[168:183]
    ds_read_b64_tr_b16 v[204:205], v25 offset:26624
    s_waitcnt vmcnt(14)
    ds_read_b64_tr_b16 a[32:33], v29 offset:4096
    ds_read_b64_tr_b16 a[34:35], v29 offset:5120
    ds_read_b64_tr_b16 a[144:145], v30 offset:4096
    ds_read_b64_tr_b16 a[146:147], v30 offset:5120
    ds_read_b64_tr_b16 a[36:37], v29 offset:6144
    v_mfma_f32_32x32x16_bf16 v[184:199], a[152:155], v[208:211], v[184:199]
    ds_read_b64_tr_b16 v[206:207], v25 offset:27136
    ds_read_b64_tr_b16 a[38:39], v29 offset:7168
    ds_read_b64_tr_b16 a[148:149], v30 offset:6144
    ds_read_b64_tr_b16 a[150:151], v30 offset:7168
    v_fma_f32 v231, -v240, v55, v151
    v_fma_f32 v216, v216, v242, v242
    s_waitcnt lgkmcnt(14)
    v_mfma_f32_32x32x16_bf16 v[168:183], a[44:47], v[212:215], v[168:183]
    ds_read_b64_tr_b16 v[208:209], v25 offset:28672
    s_waitcnt vmcnt(8)
    s_barrier
    s_mov_b32 s100, 0x11000
    v_mov_b32 v4, s93
    buffer_store_dword v4, v12, s[44:47], s100 offen sc1
    v_fma_f32 v217, v217, v242, v242
    v_mfma_f32_32x32x16_bf16 v[184:199], a[156:159], v[212:215], v[184:199]
    ds_read_b64_tr_b16 v[210:211], v25 offset:29184
    v_fma_f32 v218, v218, v242, v242
    v_fma_f32 v219, v219, v242, v242
    v_fma_f32 v220, v220, v242, v242
    v_fma_f32 v221, v221, v242, v242
    v_fma_f32 v222, v222, v242, v242
    v_fma_f32 v223, v223, v242, v242
    s_waitcnt lgkmcnt(12)
    v_mfma_f32_32x32x16_bf16 v[168:183], a[48:51], v[200:203], v[168:183]
    ds_read_b64_tr_b16 v[212:213], v25 offset:30720
    ds_read_b64_tr_b16 a[40:41], v29 offset:8192
    ds_read_b64_tr_b16 a[42:43], v29 offset:9216
    ds_read_b64_tr_b16 a[152:153], v30 offset:8192
    ds_read_b64_tr_b16 a[154:155], v30 offset:9216
    ds_read_b64_tr_b16 a[44:45], v29 offset:10240
    v_mfma_f32_32x32x16_bf16 v[184:199], a[160:163], v[200:203], v[184:199]
    ds_read_b64_tr_b16 v[214:215], v25 offset:31232
    ds_read_b64_tr_b16 a[46:47], v29 offset:11264
    ds_read_b64_tr_b16 a[156:157], v30 offset:10240
    ds_read_b64_tr_b16 a[158:159], v30 offset:11264
    v_rcp_f32 v216, v216
    s_waitcnt lgkmcnt(15)
    v_mfma_f32_32x32x16_bf16 v[168:183], a[52:55], v[204:207], v[168:183]
    ds_read_b64_tr_b16 v[200:201], v25 offset:32768
    s_add_u32 m0, s78, 4096
    s_add_u32 s75, s83, 286720
    buffer_load_dwordx4 v26, s[56:59], s75 offen offset:0 lds
    buffer_load_dwordx4 v9, s[56:59], s75 offen offset:1024 lds
    v_mfma_f32_32x32x16_bf16 v[184:199], a[164:167], v[204:207], v[184:199]
    ds_read_b64_tr_b16 v[202:203], v25 offset:33280
    buffer_load_dwordx4 v10, s[56:59], s75 offen offset:2048 lds
    v_rcp_f32 v217, v217
    v_rcp_f32 v218, v218
    s_waitcnt lgkmcnt(12)
    v_mfma_f32_32x32x16_bf16 v[168:183], a[56:59], v[208:211], v[168:183]
    ds_read_b64_tr_b16 v[204:205], v25 offset:34816
    buffer_load_dwordx4 v8, s[56:59], s75 offen offset:3072 lds
    v_rcp_f32 v219, v219
    v_rcp_f32 v220, v220
    v_mfma_f32_32x32x16_bf16 v[184:199], a[168:171], v[208:211], v[184:199]
    ds_read_b64_tr_b16 v[206:207], v25 offset:35328
    v_rcp_f32 v221, v221
    v_rcp_f32 v222, v222
    v_rcp_f32 v223, v223
    s_waitcnt lgkmcnt(7)
    v_mfma_f32_32x32x16_bf16 v[168:183], a[60:63], v[212:215], v[168:183]
    ds_read_b64_tr_b16 v[208:209], v25 offset:36864
    v_mul_f32 v224, v216, v224
    v_mul_f32 v225, v217, v225
    v_mul_f32 v226, v218, v226
    v_mul_f32 v227, v219, v227
    v_mul_f32 v228, v220, v228
    v_mul_f32 v229, v221, v229
    v_mfma_f32_32x32x16_bf16 v[184:199], a[172:175], v[212:215], v[184:199]
    ds_read_b64_tr_b16 v[210:211], v25 offset:37376
    v_mul_f32 v230, v222, v230
    v_mul_f32 v231, v223, v231
    v_cvt_pk_bf16_f32 v16, v224, v225
    v_cvt_pk_bf16_f32 v17, v226, v227
    v_cvt_pk_bf16_f32 v18, v228, v229
    s_waitcnt lgkmcnt(4)
    v_mfma_f32_32x32x16_bf16 v[168:183], a[64:67], v[200:203], v[168:183]
    ds_read_b64_tr_b16 v[212:213], v25 offset:38912
    v_cvt_pk_bf16_f32 v19, v230, v231
    s_add_u32 s73, s89, 231424
    buffer_store_dwordx4 v[16:19], v1, s[44:47], s73 offen sc1
    v_fma_f32 v216, -v240, v56, v152
    v_fma_f32 v217, -v240, v57, v153
    v_mfma_f32_32x32x16_bf16 v[184:199], a[176:179], v[200:203], v[184:199]
    ds_read_b64_tr_b16 v[214:215], v25 offset:39424
    v_fma_f32 v218, -v240, v58, v154
    v_fma_f32 v219, -v240, v59, v155
    v_fma_f32 v220, -v240, v60, v156
    v_fma_f32 v221, -v240, v61, v157
    v_fma_f32 v222, -v240, v62, v158
    v_fma_f32 v223, -v240, v63, v159
    s_waitcnt lgkmcnt(4)
    v_mfma_f32_32x32x16_bf16 v[168:183], a[68:71], v[204:207], v[168:183]
    ds_read_b64_tr_b16 v[200:201], v25 offset:40960
    s_add_u32 m0, s79, 0
    s_add_u32 s75, s83, 315392
    buffer_load_dwordx4 v26, s[56:59], s75 offen offset:0 lds
    v_mul_f32 v216, v241, v216
    v_mul_f32 v217, v241, v217
    v_mfma_f32_32x32x16_bf16 v[184:199], a[180:183], v[204:207], v[184:199]
    ds_read_b64_tr_b16 v[202:203], v25 offset:41472
    buffer_load_dwordx4 v9, s[56:59], s75 offen offset:1024 lds
    v_mul_f32 v218, v241, v218
    v_mul_f32 v219, v241, v219
    v_mul_f32 v220, v241, v220
    v_mul_f32 v221, v241, v221
    s_waitcnt lgkmcnt(4)
    v_mfma_f32_32x32x16_bf16 v[168:183], a[72:75], v[208:211], v[168:183]
    ds_read_b64_tr_b16 v[204:205], v25 offset:43008
    buffer_load_dwordx4 v10, s[56:59], s75 offen offset:2048 lds
    v_mul_f32 v222, v241, v222
    v_mul_f32 v223, v241, v223
    v_exp_f32 v216, v216
    v_mfma_f32_32x32x16_bf16 v[184:199], a[184:187], v[208:211], v[184:199]
    ds_read_b64_tr_b16 v[206:207], v25 offset:43520
    buffer_load_dwordx4 v8, s[56:59], s75 offen offset:3072 lds
    v_fma_f32 v224, -v240, v64, v160
    v_exp_f32 v217, v217
    v_fma_f32 v225, -v240, v65, v161
    s_waitcnt lgkmcnt(4)
    v_mfma_f32_32x32x16_bf16 v[168:183], a[76:79], v[212:215], v[168:183]
    ds_read_b64_tr_b16 v[208:209], v25 offset:45056
    v_exp_f32 v218, v218
    v_fma_f32 v226, -v240, v66, v162
    v_exp_f32 v219, v219
    v_fma_f32 v227, -v240, v67, v163
    v_mfma_f32_32x32x16_bf16 v[184:199], a[188:191], v[212:215], v[184:199]
    ds_read_b64_tr_b16 v[210:211], v25 offset:45568
    v_exp_f32 v220, v220
    v_fma_f32 v228, -v240, v68, v164
    v_exp_f32 v221, v221
    s_waitcnt lgkmcnt(4)
    v_mfma_f32_32x32x16_bf16 v[168:183], a[80:83], v[200:203], v[168:183]
    ds_read_b64_tr_b16 v[212:213], v25 offset:47104
    v_fma_f32 v229, -v240, v69, v165
    v_exp_f32 v222, v222
    v_fma_f32 v230, -v240, v70, v166
    v_exp_f32 v223, v223
    v_mfma_f32_32x32x16_bf16 v[184:199], a[192:195], v[200:203], v[184:199]
    ds_read_b64_tr_b16 v[214:215], v25 offset:47616
    v_fma_f32 v231, -v240, v71, v167
    v_fma_f32 v216, v216, v242, v242
    v_fma_f32 v217, v217, v242, v242
    v_fma_f32 v218, v218, v242, v242
    v_fma_f32 v219, v219, v242, v242
    s_waitcnt lgkmcnt(4)
    v_mfma_f32_32x32x16_bf16 v[168:183], a[84:87], v[204:207], v[168:183]
    ds_read_b64_tr_b16 v[200:201], v25 offset:49152
    v_fma_f32 v220, v220, v242, v242
    v_fma_f32 v221, v221, v242, v242
    v_fma_f32 v222, v222, v242, v242
    v_fma_f32 v223, v223, v242, v242
    v_rcp_f32 v216, v216
    v_mfma_f32_32x32x16_bf16 v[184:199], a[196:199], v[204:207], v[184:199]
    ds_read_b64_tr_b16 v[202:203], v25 offset:49664
    s_add_u32 m0, s79, 4096
    s_add_u32 s75, s83, 344064
    buffer_load_dwordx4 v26, s[56:59], s75 offen offset:0 lds
    s_mov_b32 s100, 0x11000
    buffer_load_dword v15, v13, s[44:47], s100 offen sc1
    s_waitcnt lgkmcnt(4)
    v_mfma_f32_32x32x16_bf16 v[168:183], a[88:91], v[208:211], v[168:183]
    ds_read_b64_tr_b16 v[204:205], v25 offset:51200
    buffer_load_dwordx4 v9, s[56:59], s75 offen offset:1024 lds
    v_rcp_f32 v217, v217
    v_rcp_f32 v218, v218
    v_mfma_f32_32x32x16_bf16 v[184:199], a[200:203], v[208:211], v[184:199]
    ds_read_b64_tr_b16 v[206:207], v25 offset:51712
    buffer_load_dwordx4 v10, s[56:59], s75 offen offset:2048 lds
    v_rcp_f32 v219, v219
    v_rcp_f32 v220, v220
    s_waitcnt lgkmcnt(4)
    v_mfma_f32_32x32x16_bf16 v[168:183], a[92:95], v[212:215], v[168:183]
    ds_read_b64_tr_b16 v[208:209], v25 offset:53248
    buffer_load_dwordx4 v8, s[56:59], s75 offen offset:3072 lds
    v_rcp_f32 v221, v221
    v_rcp_f32 v222, v222
    v_mfma_f32_32x32x16_bf16 v[184:199], a[204:207], v[212:215], v[184:199]
    ds_read_b64_tr_b16 v[210:211], v25 offset:53760
    v_rcp_f32 v223, v223
    v_mul_f32 v224, v216, v224
    v_mul_f32 v225, v217, v225
    v_mul_f32 v226, v218, v226
    s_waitcnt lgkmcnt(4)
    v_mfma_f32_32x32x16_bf16 v[168:183], a[96:99], v[200:203], v[168:183]
    ds_read_b64_tr_b16 v[212:213], v25 offset:55296
    v_mul_f32 v227, v219, v227
    v_mul_f32 v228, v220, v228
    v_mul_f32 v229, v221, v229
    v_mul_f32 v230, v222, v230
    v_mul_f32 v231, v223, v231
    v_cvt_pk_bf16_f32 v16, v224, v225
    v_mfma_f32_32x32x16_bf16 v[184:199], a[208:211], v[200:203], v[184:199]
    ds_read_b64_tr_b16 v[214:215], v25 offset:55808
    v_cvt_pk_bf16_f32 v17, v226, v227
    v_cvt_pk_bf16_f32 v18, v228, v229
    v_cvt_pk_bf16_f32 v19, v230, v231
    s_add_u32 s73, s89, 232448
    buffer_store_dwordx4 v[16:19], v1, s[44:47], s73 offen sc1
    s_waitcnt lgkmcnt(4)
    v_mfma_f32_32x32x16_bf16 v[168:183], a[100:103], v[204:207], v[168:183]
    v_mfma_f32_32x32x16_bf16 v[184:199], a[212:215], v[204:207], v[184:199]
    s_waitcnt lgkmcnt(2)
    v_mfma_f32_32x32x16_bf16 v[168:183], a[104:107], v[208:211], v[168:183]
    s_add_u32 m0, s79, 8192
    s_add_u32 s75, s83, 372736
    buffer_load_dwordx4 v26, s[56:59], s75 offen offset:0 lds
    v_mfma_f32_32x32x16_bf16 v[184:199], a[216:219], v[208:211], v[184:199]
    buffer_load_dwordx4 v9, s[56:59], s75 offen offset:1024 lds
    s_waitcnt lgkmcnt(0)
    v_mfma_f32_32x32x16_bf16 v[168:183], a[108:111], v[212:215], v[168:183]
    buffer_load_dwordx4 v10, s[56:59], s75 offen offset:2048 lds
    v_mfma_f32_32x32x16_bf16 v[184:199], a[220:223], v[212:215], v[184:199]
    buffer_load_dwordx4 v8, s[56:59], s75 offen offset:3072 lds
    s_nop 8
    v_pk_fma_f32 v[216:217], v[244:245], v[40:41], v[168:169] op_sel_hi:[0,1,1] neg_lo:[1,0,0] neg_hi:[1,0,0]
    v_pk_fma_f32 v[218:219], v[244:245], v[42:43], v[170:171] op_sel_hi:[0,1,1] neg_lo:[1,0,0] neg_hi:[1,0,0]
    v_pk_fma_f32 v[220:221], v[244:245], v[44:45], v[172:173] op_sel_hi:[0,1,1] neg_lo:[1,0,0] neg_hi:[1,0,0]
    v_pk_fma_f32 v[222:223], v[244:245], v[46:47], v[174:175] op_sel_hi:[0,1,1] neg_lo:[1,0,0] neg_hi:[1,0,0]
    v_pk_mul_f32 v[216:217], v[244:245], v[216:217] op_sel:[1,0] op_sel_hi:[1,1]
    v_pk_mul_f32 v[218:219], v[244:245], v[218:219] op_sel:[1,0] op_sel_hi:[1,1]
    v_pk_mul_f32 v[220:221], v[244:245], v[220:221] op_sel:[1,0] op_sel_hi:[1,1]
    v_pk_mul_f32 v[222:223], v[244:245], v[222:223] op_sel:[1,0] op_sel_hi:[1,1]
    v_exp_f32 v216, v216
    v_exp_f32 v217, v217
    v_pk_fma_f32 v[224:225], v[244:245], v[48:49], v[176:177] op_sel_hi:[0,1,1] neg_lo:[1,0,0] neg_hi:[1,0,0]
    v_exp_f32 v218, v218
    v_exp_f32 v219, v219
    v_pk_fma_f32 v[226:227], v[244:245], v[50:51], v[178:179] op_sel_hi:[0,1,1] neg_lo:[1,0,0] neg_hi:[1,0,0]
    v_exp_f32 v220, v220
    v_exp_f32 v221, v221
    v_pk_fma_f32 v[228:229], v[244:245], v[52:53], v[180:181] op_sel_hi:[0,1,1] neg_lo:[1,0,0] neg_hi:[1,0,0]
    v_exp_f32 v222, v222
    v_exp_f32 v223, v223
    v_pk_fma_f32 v[230:231], v[244:245], v[54:55], v[182:183] op_sel_hi:[0,1,1] neg_lo:[1,0,0] neg_hi:[1,0,0]
    v_pk_fma_f32 v[216:217], v[216:217], v[246:247], v[246:247] op_sel_hi:[1,0,0]
    v_pk_fma_f32 v[218:219], v[218:219], v[246:247], v[246:247] op_sel_hi:[1,0,0]
    v_pk_fma_f32 v[220:221], v[220:221], v[246:247], v[246:247] op_sel_hi:[1,0,0]
    v_pk_fma_f32 v[222:223], v[222:223], v[246:247], v[246:247] op_sel_hi:[1,0,0]
    v_rcp_f32 v216, v216
    v_rcp_f32 v217, v217
    v_rcp_f32 v218, v218
    v_rcp_f32 v219, v219
    v_rcp_f32 v220, v220
    v_rcp_f32 v221, v221
    v_rcp_f32 v222, v222
    v_rcp_f32 v223, v223
    v_pk_mul_f32 v[224:225], v[216:217], v[224:225]
    v_pk_mul_f32 v[226:227], v[218:219], v[226:227]
    v_pk_mul_f32 v[228:229], v[220:221], v[228:229]
    v_pk_mul_f32 v[230:231], v[222:223], v[230:231]
    v_cvt_pk_bf16_f32 v16, v224, v225
    v_cvt_pk_bf16_f32 v17, v226, v227
    v_cvt_pk_bf16_f32 v18, v228, v229
    v_cvt_pk_bf16_f32 v19, v230, v231
    s_add_u32 s73, s89, 347136
    buffer_store_dwordx4 v[16:19], v1, s[44:47], s73 offen sc1
    v_pk_fma_f32 v[216:217], v[244:245], v[56:57], v[184:185] op_sel_hi:[0,1,1] neg_lo:[1,0,0] neg_hi:[1,0,0]
    v_pk_fma_f32 v[218:219], v[244:245], v[58:59], v[186:187] op_sel_hi:[0,1,1] neg_lo:[1,0,0] neg_hi:[1,0,0]
    v_pk_fma_f32 v[220:221], v[244:245], v[60:61], v[188:189] op_sel_hi:[0,1,1] neg_lo:[1,0,0] neg_hi:[1,0,0]
    v_pk_fma_f32 v[222:223], v[244:245], v[62:63], v[190:191] op_sel_hi:[0,1,1] neg_lo:[1,0,0] neg_hi:[1,0,0]
    v_pk_mul_f32 v[216:217], v[244:245], v[216:217] op_sel:[1,0] op_sel_hi:[1,1]
    v_pk_mul_f32 v[218:219], v[244:245], v[218:219] op_sel:[1,0] op_sel_hi:[1,1]
    v_pk_mul_f32 v[220:221], v[244:245], v[220:221] op_sel:[1,0] op_sel_hi:[1,1]
    v_pk_mul_f32 v[222:223], v[244:245], v[222:223] op_sel:[1,0] op_sel_hi:[1,1]
    v_exp_f32 v216, v216
    v_exp_f32 v217, v217
    v_pk_fma_f32 v[224:225], v[244:245], v[64:65], v[192:193] op_sel_hi:[0,1,1] neg_lo:[1,0,0] neg_hi:[1,0,0]
    v_exp_f32 v218, v218
    v_exp_f32 v219, v219
    v_pk_fma_f32 v[226:227], v[244:245], v[66:67], v[194:195] op_sel_hi:[0,1,1] neg_lo:[1,0,0] neg_hi:[1,0,0]
    v_exp_f32 v220, v220
    v_exp_f32 v221, v221
    v_pk_fma_f32 v[228:229], v[244:245], v[68:69], v[196:197] op_sel_hi:[0,1,1] neg_lo:[1,0,0] neg_hi:[1,0,0]
    v_exp_f32 v222, v222
    v_exp_f32 v223, v223
    v_pk_fma_f32 v[230:231], v[244:245], v[70:71], v[198:199] op_sel_hi:[0,1,1] neg_lo:[1,0,0] neg_hi:[1,0,0]
    v_pk_fma_f32 v[216:217], v[216:217], v[246:247], v[246:247] op_sel_hi:[1,0,0]
    v_pk_fma_f32 v[218:219], v[218:219], v[246:247], v[246:247] op_sel_hi:[1,0,0]
    v_pk_fma_f32 v[220:221], v[220:221], v[246:247], v[246:247] op_sel_hi:[1,0,0]
    v_pk_fma_f32 v[222:223], v[222:223], v[246:247], v[246:247] op_sel_hi:[1,0,0]
    v_rcp_f32 v216, v216
    v_rcp_f32 v217, v217
    v_rcp_f32 v218, v218
    v_rcp_f32 v219, v219
    v_rcp_f32 v220, v220
    v_rcp_f32 v221, v221
    v_rcp_f32 v222, v222
    v_rcp_f32 v223, v223
    v_pk_mul_f32 v[224:225], v[216:217], v[224:225]
    v_pk_mul_f32 v[226:227], v[218:219], v[226:227]
    v_pk_mul_f32 v[228:229], v[220:221], v[228:229]
    v_pk_mul_f32 v[230:231], v[222:223], v[230:231]
    v_cvt_pk_bf16_f32 v16, v224, v225
    v_cvt_pk_bf16_f32 v17, v226, v227
    v_cvt_pk_bf16_f32 v18, v228, v229
    v_cvt_pk_bf16_f32 v19, v230, v231
    s_add_u32 s73, s89, 348160
    buffer_store_dwordx4 v[16:19], v1, s[44:47], s73 offen sc1
    s_waitcnt vmcnt(10)
    v_xor_b32 v15, s93, v15
    v_cmp_ne_u32 vcc, 0, v15
    s_mov_b32 s101, 0
    s_cbranch_vccz L_C1_ok
    s_mov_b32 s100, 0x11000
L_C1_spin:
    buffer_load_dword v15, v13, s[44:47], s100 offen sc1
    s_waitcnt vmcnt(0)
    v_xor_b32 v15, s93, v15
    v_cmp_ne_u32 vcc, 0, v15
    s_add_u32 s101, s101, 1
    s_cmp_gt_u32 s101, 400000
    s_cbranch_scc1 L_C1_ok
    s_cbranch_vccnz L_C1_spin
L_C1_ok:
    s_add_u32 s72, s30, 0
    buffer_load_dwordx4 v[72:75], v34, s[44:47], s72 offen sc1
    s_add_u32 s72, s30, 1024
    buffer_load_dwordx4 v[76:79], v34, s[44:47], s72 offen sc1
    s_add_u32 s72, s30, 2048
    buffer_load_dwordx4 v[80:83], v34, s[44:47], s72 offen sc1
    s_add_u32 s72, s30, 3072
    buffer_load_dwordx4 v[84:87], v34, s[44:47], s72 offen sc1
    s_add_u32 s72, s30, 4096
    buffer_load_dwordx4 v[88:91], v34, s[44:47], s72 offen sc1
    s_add_u32 s72, s30, 5120
    buffer_load_dwordx4 v[92:95], v34, s[44:47], s72 offen sc1
    s_add_u32 s72, s30, 6144
    buffer_load_dwordx4 v[96:99], v34, s[44:47], s72 offen sc1
    s_add_u32 s72, s30, 7168
    buffer_load_dwordx4 v[100:103], v34, s[44:47], s72 offen sc1
    s_add_u32 s72, s30, 8192
    buffer_load_dwordx4 v[104:107], v34, s[44:47], s72 offen sc1
    s_add_u32 s72, s30, 9216
    buffer_load_dwordx4 v[108:111], v34, s[44:47], s72 offen sc1
    s_waitcnt vmcnt(10)
    s_barrier
    s_mov_b32 s100, 0x12000
    v_mov_b32 v4, s93
    buffer_store_dword v4, v12, s[44:47], s100 offen sc1
    s_cmp_lg_u32 s2, 0
    s_cselect_b32 s73, 0x80000000, 0
    v_mov_b32 v5, s73
    v_cmp_eq_u32 vcc, 0, v0
    v_mov_b32 v6, 0x80000000
    s_nop 0
    v_cndmask_b32 v5, v6, v5, vcc
    buffer_store_dword v4, v5, s[44:47], 0 offen sc1
    s_waitcnt vmcnt(11)
    v_mfma_f32_32x32x16_bf16 v[136:151], a[224:227], v[72:75], 0
    s_add_u32 s72, s30, 10240
    buffer_load_dwordx4 v[112:115], v34, s[44:47], s72 offen sc1
    ds_read_b64_tr_b16 a[48:49], v27 offset:8192
    ds_read_b64_tr_b16 a[50:51], v27 offset:9216
    v_mfma_f32_32x32x16_bf16 v[152:167], a[228:231], v[72:75], 0
    ds_read_b64_tr_b16 a[160:161], v28 offset:8192
    ds_read_b64_tr_b16 a[162:163], v28 offset:9216
    ds_read_b64_tr_b16 a[52:53], v27 offset:10240
    ds_read_b64_tr_b16 a[54:55], v27 offset:11264
    ds_read_b64_tr_b16 a[164:165], v28 offset:10240
    s_waitcnt vmcnt(11)
    v_mfma_f32_32x32x16_bf16 v[136:151], a[232:235], v[76:79], v[136:151]
    s_add_u32 s72, s30, 11264
    buffer_load_dwordx4 v[116:119], v34, s[44:47], s72 offen sc1
    ds_read_b64_tr_b16 a[166:167], v28 offset:11264
    v_mfma_f32_32x32x16_bf16 v[152:167], a[236:239], v[76:79], v[152:167]
    ds_read_b64_tr_b16 a[56:57], v27 offset:0
    ds_read_b64_tr_b16 a[58:59], v27 offset:1024
    ds_read_b64_tr_b16 a[168:169], v28 offset:0
    ds_read_b64_tr_b16 a[170:171], v28 offset:1024
    ds_read_b64_tr_b16 a[60:61], v27 offset:2048
    s_waitcnt vmcnt(11)
    v_mfma_f32_32x32x16_bf16 v[136:151], a[240:243], v[80:83], v[136:151]
    s_add_u32 s72, s30, 12288
    buffer_load_dwordx4 v[72:75], v34, s[44:47], s72 offen sc1
    ds_read_b64_tr_b16 a[62:63], v27 offset:3072
    ds_read_b64_tr_b16 a[172:173], v28 offset:2048
    ds_read_b64_tr_b16 a[174:175], v28 offset:3072
    v_mfma_f32_32x32x16_bf16 v[152:167], a[244:247], v[80:83], v[152:167]
    s_waitcnt vmcnt(11)
    v_mfma_f32_32x32x16_bf16 v[136:151], a[248:251], v[84:87], v[136:151]
    s_add_u32 s72, s30, 13312
    buffer_load_dwordx4 v[76:79], v34, s[44:47], s72 offen sc1
    ds_read_b64_tr_b16 a[64:65], v27 offset:4096
    ds_read_b64_tr_b16 a[66:67], v27 offset:5120
    ds_read_b64_tr_b16 a[176:177], v28 offset:4096
    v_mfma_f32_32x32x16_bf16 v[152:167], a[252:255], v[84:87], v[152:167]
    ds_read_b64_tr_b16 a[178:179], v28 offset:5120
    ds_read_b64_tr_b16 a[68:69], v27 offset:6144
    ds_read_b64_tr_b16 a[70:71], v27 offset:7168
    ds_read_b64_tr_b16 a[180:181], v28 offset:6144
    ds_read_b64_tr_b16 a[182:183], v28 offset:7168
    s_waitcnt vmcnt(11)
    v_mfma_f32_32x32x16_bf16 v[136:151], a[0:3], v[88:91], v[136:151]
    s_add_u32 s72, s30, 14336
    buffer_load_dwordx4 v[80:83], v34, s[44:47], s72 offen sc1
    v_mfma_f32_32x32x16_bf16 v[152:167], a[112:115], v[88:91], v[152:167]
    ds_read_b64_tr_b16 a[72:73], v29 offset:0
    ds_read_b64_tr_b16 a[74:75], v29 offset:1024
    ds_read_b64_tr_b16 a[184:185], v30 offset:0
    ds_read_b64_tr_b16 a[186:187], v30 offset:1024
    ds_read_b64_tr_b16 a[76:77], v29 offset:2048
    s_waitcnt vmcnt(11)
    v_mfma_f32_32x32x16_bf16 v[136:151], a[4:7], v[92:95], v[136:151]
    s_add_u32 s72, s30, 15360
    buffer_load_dwordx4 v[84:87], v34, s[44:47], s72 offen sc1
    ds_read_b64_tr_b16 a[78:79], v29 offset:3072
    ds_read_b64_tr_b16 a[188:189], v30 offset:2048
    ds_read_b64_tr_b16 a[190:191], v30 offset:3072
    v_mfma_f32_32x32x16_bf16 v[152:167], a[116:119], v[92:95], v[152:167]
    s_waitcnt vmcnt(11)
    v_mfma_f32_32x32x16_bf16 v[136:151], a[8:11], v[96:99], v[136:151]
    s_add_u32 s72, s30, 16384
    buffer_load_dwordx4 v[88:91], v34, s[44:47], s72 offen sc1
    ds_read_b64_tr_b16 a[80:81], v29 offset:4096
    ds_read_b64_tr_b16 a[82:83], v29 offset:5120
    ds_read_b64_tr_b16 a[192:193], v30 offset:4096
    v_mfma_f32_32x32x16_bf16 v[152:167], a[120:123], v[96:99], v[152:167]
    ds_read_b64_tr_b16 a[194:195], v30 offset:5120
    ds_read_b64_tr_b16 a[84:85], v29 offset:6144
    ds_read_b64_tr_b16 a[86:87], v29 offset:7168
    ds_read_b64_tr_b16 a[196:197], v30 offset:6144
    ds_read_b64_tr_b16 a[198:199], v30 offset:7168
    s_waitcnt vmcnt(11)
    v_mfma_f32_32x32x16_bf16 v[136:151], a[12:15], v[100:103], v[136:151]
    s_add_u32 s72, s30, 17408
    buffer_load_dwordx4 v[92:95], v34, s[44:47], s72 offen sc1
    v_mfma_f32_32x32x16_bf16 v[152:167], a[124:127], v[100:103], v[152:167]
    ds_read_b64_tr_b16 a[88:89], v29 offset:8192
    ds_read_b64_tr_b16 a[90:91], v29 offset:9216
    ds_read_b64_tr_b16 a[200:201], v30 offset:8192
    ds_read_b64_tr_b16 a[202:203], v30 offset:9216
    ds_read_b64_tr_b16 a[92:93], v29 offset:10240
    s_waitcnt vmcnt(11)
    v_mfma_f32_32x32x16_bf16 v[136:151], a[16:19], v[104:107], v[136:151]
    s_add_u32 s72, s30, 18432
    buffer_load_dwordx4 v[96:99], v34, s[44:47], s72 offen sc1
    ds_read_b64_tr_b16 a[94:95], v29 offset:11264
    ds_read_b64_tr_b16 a[204:205], v30 offset:10240
    ds_read_b64_tr_b16 a[206:207], v30 offset:11264
    v_mfma_f32_32x32x16_bf16 v[152:167], a[128:131], v[104:107], v[152:167]
    s_waitcnt vmcnt(11)
    v_mfma_f32_32x32x16_bf16 v[136:151], a[20:23], v[108:111], v[136:151]
    s_add_u32 s72, s30, 19456
    buffer_load_dwordx4 v[100:103], v34, s[44:47], s72 offen sc1
    v_mfma_f32_32x32x16_bf16 v[152:167], a[132:135], v[108:111], v[152:167]
    s_waitcnt vmcnt(9)
    v_mfma_f32_32x32x16_bf16 v[136:151], a[24:27], v[112:115], v[136:151]
    s_add_u32 s72, s30, 20480
    buffer_load_dwordx4 v[104:107], v34, s[44:47], s72 offen sc1
    s_mov_b32 s100, 0x12000
    buffer_load_dword v15, v13, s[44:47], s100 offen sc1
    v_mfma_f32_32x32x16_bf16 v[152:167], a[136:139], v[112:115], v[152:167]
    s_waitcnt vmcnt(10)
    v_mfma_f32_32x32x16_bf16 v[136:151], a[28:31], v[116:119], v[136:151]
    s_add_u32 s72, s30, 21504
    buffer_load_dwordx4 v[108:111], v34, s[44:47], s72 offen sc1
    v_mfma_f32_32x32x16_bf16 v[152:167], a[140:143], v[116:119], v[152:167]
    s_waitcnt vmcnt(10)
    v_mfma_f32_32x32x16_bf16 v[136:151], a[32:35], v[72:75], v[136:151]
    s_add_u32 s72, s30, 22528
    buffer_load_dwordx4 v[112:115], v34, s[44:47], s72 offen sc1
    v_mfma_f32_32x32x16_bf16 v[152:167], a[144:147], v[72:75], v[152:167]
    s_waitcnt vmcnt(10)
    v_mfma_f32_32x32x16_bf16 v[136:151], a[36:39], v[76:79], v[136:151]
    s_add_u32 s72, s30, 23552
    buffer_load_dwordx4 v[116:119], v34, s[44:47], s72 offen sc1
    v_mfma_f32_32x32x16_bf16 v[152:167], a[148:151], v[76:79], v[152:167]
    s_waitcnt vmcnt(10)
    v_mfma_f32_32x32x16_bf16 v[136:151], a[40:43], v[80:83], v[136:151]
    s_add_u32 s72, s30, 24576
    buffer_load_dwordx4 v[72:75], v34, s[44:47], s72 offen sc1
    v_mfma_f32_32x32x16_bf16 v[152:167], a[152:155], v[80:83], v[152:167]
    s_waitcnt vmcnt(10)
    v_mfma_f32_32x32x16_bf16 v[136:151], a[44:47], v[84:87], v[136:151]
    s_add_u32 s72, s30, 25600
    buffer_load_dwordx4 v[76:79], v34, s[44:47], s72 offen sc1
    v_mfma_f32_32x32x16_bf16 v[152:167], a[156:159], v[84:87], v[152:167]
    s_waitcnt vmcnt(10) lgkmcnt(15)
    v_mfma_f32_32x32x16_bf16 v[136:151], a[48:51], v[88:91], v[136:151]
    s_add_u32 s72, s30, 26624
    buffer_load_dwordx4 v[80:83], v34, s[44:47], s72 offen sc1
    v_mfma_f32_32x32x16_bf16 v[152:167], a[160:163], v[88:91], v[152:167]
    s_waitcnt vmcnt(10)
    v_mfma_f32_32x32x16_bf16 v[136:151], a[52:55], v[92:95], v[136:151]
    s_add_u32 s72, s30, 27648
    buffer_load_dwordx4 v[84:87], v34, s[44:47], s72 offen sc1
    v_mfma_f32_32x32x16_bf16 v[152:167], a[164:167], v[92:95], v[152:167]
    s_waitcnt vmcnt(10)
    v_mfma_f32_32x32x16_bf16 v[136:151], a[56:59], v[96:99], v[136:151]
    v_mfma_f32_32x32x16_bf16 v[152:167], a[168:171], v[96:99], v[152:167]
    s_waitcnt vmcnt(9)
    v_mfma_f32_32x32x16_bf16 v[136:151], a[60:63], v[100:103], v[136:151]
    s_waitcnt vmcnt(7)
    v_xor_b32 v15, s93, v15
    v_cmp_ne_u32 vcc, 0, v15
    s_mov_b32 s101, 0
    s_cbranch_vccz L_C2_ok
    s_mov_b32 s100, 0x12000
L_C2_spin:
    buffer_load_dword v15, v13, s[44:47], s100 offen sc1
    s_waitcnt vmcnt(0)
    v_xor_b32 v15, s93, v15
    v_cmp_ne_u32 vcc, 0, v15
    s_add_u32 s101, s101, 1
    s_cmp_gt_u32 s101, 400000
    s_cbranch_scc1 L_C2_ok
    s_cbranch_vccnz L_C2_spin
L_C2_ok:
    v_mfma_f32_32x32x16_bf16 v[152:167], a[172:175], v[100:103], v[152:167]
    s_add_u32 s72, s30, 231424
    buffer_load_dwordx4 v[88:91], v34, s[44:47], s72 offen sc1
    v_mfma_f32_32x32x16_bf16 v[136:151], a[64:67], v[104:107], v[136:151]
    s_add_u32 s72, s30, 232448
    buffer_load_dwordx4 v[92:95], v34, s[44:47], s72 offen sc1
    v_mfma_f32_32x32x16_bf16 v[152:167], a[176:179], v[104:107], v[152:167]
    s_add_u32 s72, s30, 233472
    buffer_load_dwordx4 v[96:99], v34, s[44:47], s72 offen sc1
    s_waitcnt vmcnt(9)
    v_mfma_f32_32x32x16_bf16 v[136:151], a[68:71], v[108:111], v[136:151]
    s_add_u32 s72, s30, 234496
    buffer_load_dwordx4 v[100:103], v34, s[44:47], s72 offen sc1
    v_mfma_f32_32x32x16_bf16 v[152:167], a[180:183], v[108:111], v[152:167]
    s_waitcnt vmcnt(9)
    v_mfma_f32_32x32x16_bf16 v[136:151], a[72:75], v[112:115], v[136:151]
    s_add_u32 s72, s30, 235520
    buffer_load_dwordx4 v[104:107], v34, s[44:47], s72 offen sc1
    v_mfma_f32_32x32x16_bf16 v[152:167], a[184:187], v[112:115], v[152:167]
    s_waitcnt vmcnt(9)
    v_mfma_f32_32x32x16_bf16 v[136:151], a[76:79], v[116:119], v[136:151]
    s_add_u32 s72, s30, 236544
    buffer_load_dwordx4 v[108:111], v34, s[44:47], s72 offen sc1
    v_mfma_f32_32x32x16_bf16 v[152:167], a[188:191], v[116:119], v[152:167]
    s_waitcnt vmcnt(9) lgkmcnt(14)
    v_mfma_f32_32x32x16_bf16 v[136:151], a[80:83], v[72:75], v[136:151]
    s_add_u32 s72, s30, 237568
    buffer_load_dwordx4 v[112:115], v34, s[44:47], s72 offen sc1
    s_waitcnt lgkmcnt(12)
    v_mfma_f32_32x32x16_bf16 v[152:167], a[192:195], v[72:75], v[152:167]
    s_waitcnt vmcnt(9) lgkmcnt(10)
    v_mfma_f32_32x32x16_bf16 v[136:151], a[84:87], v[76:79], v[136:151]
    s_add_u32 s72, s30, 238592
    buffer_load_dwordx4 v[116:119], v34, s[44:47], s72 offen sc1
    s_waitcnt lgkmcnt(8)
    v_mfma_f32_32x32x16_bf16 v[152:167], a[196:199], v[76:79], v[152:167]
    s_waitcnt vmcnt(9) lgkmcnt(6)
    v_mfma_f32_32x32x16_bf16 v[136:151], a[88:91], v[80:83], v[136:151]
    s_add_u32 s72, s30, 239616
    buffer_load_dwordx4 v[72:75], v34, s[44:47], s72 offen sc1
    s_waitcnt lgkmcnt(4)
    v_mfma_f32_32x32x16_bf16 v[152:167], a[200:203], v[80:83], v[152:167]
    s_waitcnt vmcnt(9) lgkmcnt(2)
    v_mfma_f32_32x32x16_bf16 v[136:151], a[92:95], v[84:87], v[136:151]
    s_add_u32 s72, s30, 240640
    buffer_load_dwordx4 v[76:79], v34, s[44:47], s72 offen sc1
    s_waitcnt lgkmcnt(0)
    s_barrier
    v_mfma_f32_32x32x16_bf16 v[152:167], a[204:207], v[84:87], v[152:167]
    s_waitcnt vmcnt(9)
    v_mfma_f32_32x32x16_bf16 v[168:183], a[224:227], v[88:91], 0
    s_add_u32 s72, s30, 241664
    buffer_load_dwordx4 v[80:83], v34, s[44:47], s72 offen sc1
    v_mfma_f32_32x32x16_bf16 v[184:199], a[228:231], v[88:91], 0
    s_waitcnt vmcnt(9)
    v_mfma_f32_32x32x16_bf16 v[168:183], a[232:235], v[92:95], v[168:183]
    s_add_u32 s72, s30, 242688
    buffer_load_dwordx4 v[84:87], v34, s[44:47], s72 offen sc1
    v_mfma_f32_32x32x16_bf16 v[184:199], a[236:239], v[92:95], v[184:199]
    s_waitcnt vmcnt(9)
    v_mfma_f32_32x32x16_bf16 v[168:183], a[240:243], v[96:99], v[168:183]
    s_add_u32 s72, s30, 243712
    buffer_load_dwordx4 v[88:91], v34, s[44:47], s72 offen sc1
    ds_write_b128 v35, v[136:139] offset:0
    v_mfma_f32_32x32x16_bf16 v[184:199], a[244:247], v[96:99], v[184:199]
    s_waitcnt vmcnt(9)
    v_mfma_f32_32x32x16_bf16 v[168:183], a[248:251], v[100:103], v[168:183]
    s_add_u32 s72, s30, 244736
    buffer_load_dwordx4 v[92:95], v34, s[44:47], s72 offen sc1
    v_mfma_f32_32x32x16_bf16 v[184:199], a[252:255], v[100:103], v[184:199]
    ds_write_b128 v35, v[140:143] offset:32
    s_waitcnt vmcnt(9)
    v_mfma_f32_32x32x16_bf16 v[168:183], a[0:3], v[104:107], v[168:183]
    s_add_u32 s72, s30, 245760
    buffer_load_dwordx4 v[96:99], v34, s[44:47], s72 offen sc1
    v_mfma_f32_32x32x16_bf16 v[184:199], a[112:115], v[104:107], v[184:199]
    s_waitcnt vmcnt(9)
    v_mfma_f32_32x32x16_bf16 v[168:183], a[4:7], v[108:111], v[168:183]
    s_add_u32 s72, s30, 246784
    buffer_load_dwordx4 v[100:103], v34, s[44:47], s72 offen sc1
    ds_write_b128 v35, v[144:147] offset:64
    v_mfma_f32_32x32x16_bf16 v[184:199], a[116:119], v[108:111], v[184:199]
    s_waitcnt vmcnt(9)
    v_mfma_f32_32x32x16_bf16 v[168:183], a[8:11], v[112:115], v[168:183]
    s_add_u32 s72, s30, 247808
    buffer_load_dwordx4 v[104:107], v34, s[44:47], s72 offen sc1
    v_mfma_f32_32x32x16_bf16 v[184:199], a[120:123], v[112:115], v[184:199]
    ds_write_b128 v35, v[148:151] offset:96
    s_waitcnt vmcnt(9)
    v_mfma_f32_32x32x16_bf16 v[168:183], a[12:15], v[116:119], v[168:183]
    s_add_u32 s72, s30, 248832
    buffer_load_dwordx4 v[108:111], v34, s[44:47], s72 offen sc1
    v_mfma_f32_32x32x16_bf16 v[184:199], a[124:127], v[116:119], v[184:199]
    s_waitcnt vmcnt(9)
    v_mfma_f32_32x32x16_bf16 v[168:183], a[16:19], v[72:75], v[168:183]
    s_add_u32 s72, s30, 249856
    buffer_load_dwordx4 v[112:115], v34, s[44:47], s72 offen sc1
    ds_write_b128 v35, v[152:155] offset:128
    v_mfma_f32_32x32x16_bf16 v[184:199], a[128:131], v[72:75], v[184:199]
    s_waitcnt vmcnt(9)
    v_mfma_f32_32x32x16_bf16 v[168:183], a[20:23], v[76:79], v[168:183]
    s_add_u32 s72, s30, 250880
    buffer_load_dwordx4 v[116:119], v34, s[44:47], s72 offen sc1
    v_mfma_f32_32x32x16_bf16 v[184:199], a[132:135], v[76:79], v[184:199]
    ds_write_b128 v35, v[156:159] offset:160
    s_waitcnt vmcnt(9)
    v_mfma_f32_32x32x16_bf16 v[168:183], a[24:27], v[80:83], v[168:183]
    s_add_u32 s72, s30, 251904
    buffer_load_dwordx4 v[72:75], v34, s[44:47], s72 offen sc1
    v_mfma_f32_32x32x16_bf16 v[184:199], a[136:139], v[80:83], v[184:199]
    s_waitcnt vmcnt(9)
    v_mfma_f32_32x32x16_bf16 v[168:183], a[28:31], v[84:87], v[168:183]
    s_add_u32 s72, s30, 252928
    buffer_load_dwordx4 v[76:79], v34, s[44:47], s72 offen sc1
    ds_write_b128 v35, v[160:163] offset:192
    v_mfma_f32_32x32x16_bf16 v[184:199], a[140:143], v[84:87], v[184:199]
    s_waitcnt vmcnt(9)
    v_mfma_f32_32x32x16_bf16 v[168:183], a[32:35], v[88:91], v[168:183]
    s_add_u32 s72, s30, 253952
    buffer_load_dwordx4 v[80:83], v34, s[44:47], s72 offen sc1
    v_mfma_f32_32x32x16_bf16 v[184:199], a[144:147], v[88:91], v[184:199]
    ds_write_b128 v35, v[164:167] offset:224
    s_waitcnt vmcnt(9)
    v_mfma_f32_32x32x16_bf16 v[168:183], a[36:39], v[92:95], v[168:183]
    s_add_u32 s72, s30, 254976
    buffer_load_dwordx4 v[84:87], v34, s[44:47], s72 offen sc1
    v_mfma_f32_32x32x16_bf16 v[184:199], a[148:151], v[92:95], v[184:199]
    s_waitcnt vmcnt(9)
    v_mfma_f32_32x32x16_bf16 v[168:183], a[40:43], v[96:99], v[168:183]
    s_add_u32 s72, s30, 256000
    buffer_load_dwordx4 v[88:91], v34, s[44:47], s72 offen sc1
    v_mfma_f32_32x32x16_bf16 v[184:199], a[152:155], v[96:99], v[184:199]
    s_waitcnt vmcnt(9)
    v_mfma_f32_32x32x16_bf16 v[168:183], a[44:47], v[100:103], v[168:183]
    s_add_u32 s72, s30, 257024
    buffer_load_dwordx4 v[92:95], v34, s[44:47], s72 offen sc1
    v_mfma_f32_32x32x16_bf16 v[184:199], a[156:159], v[100:103], v[184:199]
    s_waitcnt lgkmcnt(0)
    s_barrier
    ds_read_b64_tr_b16 v[200:201], v37 offset:0
    s_waitcnt vmcnt(9)
    v_mfma_f32_32x32x16_bf16 v[168:183], a[48:51], v[104:107], v[168:183]
    s_add_u32 s72, s30, 258048
    buffer_load_dwordx4 v[96:99], v34, s[44:47], s72 offen sc1
    ds_read_b64_tr_b16 v[202:203], v37 offset:256
    v_mfma_f32_32x32x16_bf16 v[184:199], a[160:163], v[104:107], v[184:199]
    ds_read_b128 v[40:43], v36 offset:0
    s_waitcnt vmcnt(9)
    v_mfma_f32_32x32x16_bf16 v[168:183], a[52:55], v[108:111], v[168:183]
    s_add_u32 s72, s30, 259072
    buffer_load_dwordx4 v[100:103], v34, s[44:47], s72 offen sc1
    ds_read_b128 v[44:47], v36 offset:16
    v_mfma_f32_32x32x16_bf16 v[184:199], a[164:167], v[108:111], v[184:199]
    ds_read_b128 v[48:51], v36 offset:8704
    s_waitcnt vmcnt(9)
    v_mfma_f32_32x32x16_bf16 v[168:183], a[56:59], v[112:115], v[168:183]
    ds_read_b128 v[52:55], v36 offset:8720
    v_mfma_f32_32x32x16_bf16 v[184:199], a[168:171], v[112:115], v[184:199]
    ds_read_b128 v[56:59], v36 offset:17408
    s_waitcnt vmcnt(8)
    v_mfma_f32_32x32x16_bf16 v[168:183], a[60:63], v[116:119], v[168:183]
    ds_read_b128 v[60:63], v36 offset:17424
    v_mfma_f32_32x32x16_bf16 v[184:199], a[172:175], v[116:119], v[184:199]
    ds_read_b128 v[64:67], v36 offset:26112
    s_waitcnt vmcnt(7)
    v_mfma_f32_32x32x16_bf16 v[168:183], a[64:67], v[72:75], v[168:183]
    ds_read_b128 v[68:71], v36 offset:26128
    v_mfma_f32_32x32x16_bf16 v[184:199], a[176:179], v[72:75], v[184:199]
    s_waitcnt vmcnt(6)
    v_mfma_f32_32x32x16_bf16 v[168:183], a[68:71], v[76:79], v[168:183]
    v_mfma_f32_32x32x16_bf16 v[184:199], a[180:183], v[76:79], v[184:199]
    s_waitcnt vmcnt(5)
    v_mfma_f32_32x32x16_bf16 v[168:183], a[72:75], v[80:83], v[168:183]
    v_mfma_f32_32x32x16_bf16 v[184:199], a[184:187], v[80:83], v[184:199]
    s_waitcnt lgkmcnt(9)
    v_lshlrev_b32 v204, 16, v200
    v_and_b32 v205, 0xffff0000, v200
    v_lshlrev_b32 v206, 16, v201
    v_and_b32 v207, 0xffff0000, v201
    s_waitcnt lgkmcnt(8)
    v_lshlrev_b32 v208, 16, v202
    v_and_b32 v209, 0xffff0000, v202
    s_waitcnt vmcnt(4)
    v_mfma_f32_32x32x16_bf16 v[168:183], a[76:79], v[84:87], v[168:183]
    v_lshlrev_b32 v210, 16, v203
    v_and_b32 v211, 0xffff0000, v203
    s_waitcnt lgkmcnt(7)
    v_add_f32 v204, v204, v40
    v_add_f32 v205, v205, v41
    v_add_f32 v206, v206, v42
    v_mfma_f32_32x32x16_bf16 v[184:199], a[188:191], v[84:87], v[184:199]
    v_add_f32 v207, v207, v43
    s_waitcnt lgkmcnt(6)
    v_add_f32 v208, v208, v44
    v_add_f32 v209, v209, v45
    v_add_f32 v210, v210, v46
    v_add_f32 v211, v211, v47
    s_waitcnt vmcnt(3)
    v_mfma_f32_32x32x16_bf16 v[168:183], a[80:83], v[88:91], v[168:183]
    s_waitcnt lgkmcnt(5)
    v_add_f32 v204, v204, v48
    v_add_f32 v205, v205, v49
    v_add_f32 v206, v206, v50
    v_add_f32 v207, v207, v51
    s_waitcnt lgkmcnt(4)
    v_add_f32 v208, v208, v52
    s_waitcnt vmcnt(2)
    v_mfma_f32_32x32x16_bf16 v[168:183], a[84:87], v[92:95], v[168:183]
    v_add_f32 v209, v209, v53
    v_add_f32 v210, v210, v54
    v_add_f32 v211, v211, v55
    s_waitcnt lgkmcnt(3)
    v_add_f32 v204, v204, v56
    v_add_f32 v205, v205, v57
    s_waitcnt vmcnt(1)
    v_mfma_f32_32x32x16_bf16 v[168:183], a[88:91], v[96:99], v[168:183]
    v_add_f32 v206, v206, v58
    v_add_f32 v207, v207, v59
    s_waitcnt lgkmcnt(2)
    v_add_f32 v208, v208, v60
    v_add_f32 v209, v209, v61
    v_add_f32 v210, v210, v62
    s_waitcnt vmcnt(0)
    v_mfma_f32_32x32x16_bf16 v[168:183], a[92:95], v[100:103], v[168:183]
    v_add_f32 v211, v211, v63
    s_waitcnt lgkmcnt(1)
    v_add_f32 v204, v204, v64
    v_add_f32 v205, v205, v65
    v_add_f32 v206, v206, v66
    v_add_f32 v207, v207, v67
    v_mfma_f32_32x32x16_bf16 v[184:199], a[192:195], v[88:91], v[184:199]
    s_waitcnt lgkmcnt(0)
    v_add_f32 v208, v208, v68
    v_add_f32 v209, v209, v69
    v_add_f32 v210, v210, v70
    v_add_f32 v211, v211, v71
    v_cvt_pk_bf16_f32 v212, v204, v205
    v_mfma_f32_32x32x16_bf16 v[184:199], a[196:199], v[92:95], v[184:199]
    v_cvt_pk_bf16_f32 v213, v206, v207
    v_cvt_pk_bf16_f32 v214, v208, v209
    v_cvt_pk_bf16_f32 v215, v210, v211
    s_mov_b32 s73, 0
    v_mfma_f32_32x32x16_bf16 v[184:199], a[200:203], v[96:99], v[184:199]
    buffer_store_dwordx4 v[212:215], v38, s[60:63], s73 offen
    ds_write_b128 v35, v[168:171] offset:34816
    ds_write_b128 v35, v[172:175] offset:34848
    ds_write_b128 v35, v[176:179] offset:34880
    ds_write_b128 v35, v[180:183] offset:34912
    v_mfma_f32_32x32x16_bf16 v[184:199], a[204:207], v[100:103], v[184:199]
    s_nop 11
    ds_write_b128 v35, v[184:187] offset:34944
    ds_write_b128 v35, v[188:191] offset:34976
    ds_write_b128 v35, v[192:195] offset:35008
    ds_write_b128 v35, v[196:199] offset:35040
    s_waitcnt lgkmcnt(0)
    s_barrier
    ds_read_b64_tr_b16 v[200:201], v37 offset:4096
    ds_read_b64_tr_b16 v[202:203], v37 offset:4352
    ds_read_b128 v[40:43], v36 offset:34816
    ds_read_b128 v[44:47], v36 offset:34832
    ds_read_b128 v[48:51], v36 offset:43520
    ds_read_b128 v[52:55], v36 offset:43536
    ds_read_b128 v[56:59], v36 offset:52224
    ds_read_b128 v[60:63], v36 offset:52240
    ds_read_b128 v[64:67], v36 offset:60928
    ds_read_b128 v[68:71], v36 offset:60944
    s_waitcnt lgkmcnt(9)
    v_lshlrev_b32 v204, 16, v200
    v_and_b32 v205, 0xffff0000, v200
    v_lshlrev_b32 v206, 16, v201
    v_and_b32 v207, 0xffff0000, v201
    s_waitcnt lgkmcnt(8)
    v_lshlrev_b32 v208, 16, v202
    v_and_b32 v209, 0xffff0000, v202
    v_lshlrev_b32 v210, 16, v203
    v_and_b32 v211, 0xffff0000, v203
    s_waitcnt lgkmcnt(7)
    v_pk_add_f32 v[204:205], v[204:205], v[40:41]
    v_pk_add_f32 v[206:207], v[206:207], v[42:43]
    s_waitcnt lgkmcnt(6)
    v_pk_add_f32 v[208:209], v[208:209], v[44:45]
    v_pk_add_f32 v[210:211], v[210:211], v[46:47]
    s_waitcnt lgkmcnt(5)
    v_pk_add_f32 v[204:205], v[204:205], v[48:49]
    v_pk_add_f32 v[206:207], v[206:207], v[50:51]
    s_waitcnt lgkmcnt(4)
    v_pk_add_f32 v[208:209], v[208:209], v[52:53]
    v_pk_add_f32 v[210:211], v[210:211], v[54:55]
    s_waitcnt lgkmcnt(3)
    v_pk_add_f32 v[204:205], v[204:205], v[56:57]
    v_pk_add_f32 v[206:207], v[206:207], v[58:59]
    s_waitcnt lgkmcnt(2)
    v_pk_add_f32 v[208:209], v[208:209], v[60:61]
    v_pk_add_f32 v[210:211], v[210:211], v[62:63]
    s_waitcnt lgkmcnt(1)
    v_pk_add_f32 v[204:205], v[204:205], v[64:65]
    v_pk_add_f32 v[206:207], v[206:207], v[66:67]
    s_waitcnt lgkmcnt(0)
    v_pk_add_f32 v[208:209], v[208:209], v[68:69]
    v_pk_add_f32 v[210:211], v[210:211], v[70:71]
    v_cvt_pk_bf16_f32 v212, v204, v205
    v_cvt_pk_bf16_f32 v213, v206, v207
    v_cvt_pk_bf16_f32 v214, v208, v209
    v_cvt_pk_bf16_f32 v215, v210, v211
    s_mov_b32 s73, 57344
    buffer_store_dwordx4 v[212:215], v38, s[60:63], s73 offen
    s_waitcnt vmcnt(0)
    s_endpgm
L_helper:
    s_mov_b32 s44, s28
    s_and_b32 s45, s29, 0xffff
    s_mov_b32 s46, 0xe20000
    s_mov_b32 s47, 0x20000
    s_getpc_b64 s[94:95]
L_pc2:
    v_lshlrev_b32 v4, 7, v0
    v_min_u32 v4, L_end-L_pc2, v4
    v_mov_b32 v5, s95
    v_add_co_u32 v4, vcc, s94, v4
    s_nop 1
    v_addc_co_u32 v5, vcc, 0, v5, vcc
    global_load_dword v1, v[4:5], off
    v_mov_b32 v16, s40
    v_mov_b32 v17, s41
    v_writelane_b32 v16, s12, 1
    v_writelane_b32 v17, s13, 1
    v_writelane_b32 v16, s4, 2
    v_writelane_b32 v17, s5, 2
    v_writelane_b32 v16, s36, 3
    v_writelane_b32 v17, s37, 3
    global_load_ubyte v18, v[16:17], off
    v_mov_b32 v20, 0x80000000
    s_mov_b32 s72, 0x4f0000
    v_writelane_b32 v20, s72, 0
    s_mov_b32 s72, 0x6f0000
    v_writelane_b32 v20, s72, 1
    buffer_load_dword v22, v20, s[44:47], 0 offen
    v_mul_u32_u24 v20, 917500, v0
    v_mov_b32 v21, 0x80000000
    v_cmp_gt_u32 vcc, 3, v0
    s_nop 1
    v_cndmask_b32 v20, v21, v20, vcc
    buffer_load_dword v23, v20, s[60:63], 0 offen
    s_sub_u32 s72, s2, 224
    s_lshl_b32 s72, s72, 6
    v_lshrrev_b32 v29, 4, v0
    v_add_u32 v29, s72, v29
    v_and_b32 v28, 15, v0
    v_mul_u32_u24 v30, 896, v29
    v_lshl_add_u32 v30, v28, 4, v30
    v_mov_b32 v32, 0x80000000
    v_cmp_gt_u32 vcc, 8, v28
    s_nop 1
    v_cndmask_b32 v31, v32, v30, vcc
    s_mov_b32 s73, 0
    buffer_load_dwordx4 v[36:39], v30, s[32:35], s73 offen offset:0
    buffer_load_dwordx4 v[40:43], v30, s[32:35], s73 offen offset:256
    buffer_load_dwordx4 v[44:47], v30, s[32:35], s73 offen offset:512
    buffer_load_dwordx4 v[48:51], v31, s[32:35], s73 offen offset:768
    s_mov_b32 s73, 14336
    buffer_load_dwordx4 v[52:55], v30, s[32:35], s73 offen offset:0
    buffer_load_dwordx4 v[56:59], v30, s[32:35], s73 offen offset:256
    buffer_load_dwordx4 v[60:63], v30, s[32:35], s73 offen offset:512
    buffer_load_dwordx4 v[64:67], v31, s[32:35], s73 offen offset:768
    s_mov_b32 s73, 28672
    buffer_load_dwordx4 v[68:71], v30, s[32:35], s73 offen offset:0
    buffer_load_dwordx4 v[72:75], v30, s[32:35], s73 offen offset:256
    buffer_load_dwordx4 v[76:79], v30, s[32:35], s73 offen offset:512
    buffer_load_dwordx4 v[80:83], v31, s[32:35], s73 offen offset:768
    s_mov_b32 s73, 43008
    buffer_load_dwordx4 v[84:87], v30, s[32:35], s73 offen offset:0
    buffer_load_dwordx4 v[88:91], v30, s[32:35], s73 offen offset:256
    buffer_load_dwordx4 v[92:95], v30, s[32:35], s73 offen offset:512
    buffer_load_dwordx4 v[96:99], v31, s[32:35], s73 offen offset:768
    v_add_u32 v100, 0, v29
    v_lshrrev_b32 v101, 10, v100
    v_lshlrev_b32 v101, 13, v101
    v_bfe_u32 v102, v100, 3, 2
    v_add_u32 v103, 1, v102
    v_bfe_u32 v103, v103, 1, 1
    v_lshl_add_u32 v101, v103, 12, v101
    v_and_b32 v102, 1, v102
    v_lshl_add_u32 v101, v102, 9, v101
    v_bfe_u32 v102, v100, 1, 2
    v_lshl_add_u32 v101, v102, 10, v101
    v_bfe_u32 v102, v100, 5, 5
    v_lshl_add_u32 v101, v102, 4, v101
    v_and_b32 v102, 1, v100
    v_lshl_add_u32 v101, v102, 3, v101
    v_add_u32 v101, 0x40000, v101
    v_cmp_eq_u32 vcc, 0, v28
    v_mov_b32 v32, 0x80000000
    s_nop 0
    v_cndmask_b32 v101, v32, v101, vcc
    v_add_u32 v104, 16, v29
    v_lshrrev_b32 v105, 10, v104
    v_lshlrev_b32 v105, 13, v105
    v_bfe_u32 v106, v104, 3, 2
    v_add_u32 v107, 1, v106
    v_bfe_u32 v107, v107, 1, 1
    v_lshl_add_u32 v105, v107, 12, v105
    v_and_b32 v106, 1, v106
    v_lshl_add_u32 v105, v106, 9, v105
    v_bfe_u32 v106, v104, 1, 2
    v_lshl_add_u32 v105, v106, 10, v105
    v_bfe_u32 v106, v104, 5, 5
    v_lshl_add_u32 v105, v106, 4, v105
    v_and_b32 v106, 1, v104
    v_lshl_add_u32 v105, v106, 3, v105
    v_add_u32 v105, 0x40000, v105
    v_cmp_eq_u32 vcc, 0, v28
    v_mov_b32 v32, 0x80000000
    s_nop 0
    v_cndmask_b32 v105, v32, v105, vcc
    v_add_u32 v108, 32, v29
    v_lshrrev_b32 v109, 10, v108
    v_lshlrev_b32 v109, 13, v109
    v_bfe_u32 v110, v108, 3, 2
    v_add_u32 v111, 1, v110
    v_bfe_u32 v111, v111, 1, 1
    v_lshl_add_u32 v109, v111, 12, v109
    v_and_b32 v110, 1, v110
    v_lshl_add_u32 v109, v110, 9, v109
    v_bfe_u32 v110, v108, 1, 2
    v_lshl_add_u32 v109, v110, 10, v109
    v_bfe_u32 v110, v108, 5, 5
    v_lshl_add_u32 v109, v110, 4, v109
    v_and_b32 v110, 1, v108
    v_lshl_add_u32 v109, v110, 3, v109
    v_add_u32 v109, 0x40000, v109
    v_cmp_eq_u32 vcc, 0, v28
    v_mov_b32 v32, 0x80000000
    s_nop 0
    v_cndmask_b32 v109, v32, v109, vcc
    v_add_u32 v112, 48, v29
    v_lshrrev_b32 v113, 10, v112
    v_lshlrev_b32 v113, 13, v113
    v_bfe_u32 v114, v112, 3, 2
    v_add_u32 v115, 1, v114
    v_bfe_u32 v115, v115, 1, 1
    v_lshl_add_u32 v113, v115, 12, v113
    v_and_b32 v114, 1, v114
    v_lshl_add_u32 v113, v114, 9, v113
    v_bfe_u32 v114, v112, 1, 2
    v_lshl_add_u32 v113, v114, 10, v113
    v_bfe_u32 v114, v112, 5, 5
    v_lshl_add_u32 v113, v114, 4, v113
    v_and_b32 v114, 1, v112
    v_lshl_add_u32 v113, v114, 3, v113
    v_add_u32 v113, 0x40000, v113
    v_cmp_eq_u32 vcc, 0, v28
    v_mov_b32 v32, 0x80000000
    s_nop 0
    v_cndmask_b32 v113, v32, v113, vcc
    v_mov_b32 v4, 0
    buffer_load_dword v8, v4, s[44:47], 0 offen sc1
    s_mov_b32 s48, s18
    s_and_b32 s49, s19, 0xffff
    s_mov_b32 s50, 0x188000
    s_mov_b32 s51, 0x20000
    s_mov_b32 s52, s20
    s_and_b32 s53, s21, 0xffff
    s_mov_b32 s54, 0x188000
    s_mov_b32 s55, 0x20000
    s_mov_b32 s56, s22
    s_and_b32 s57, s23, 0xffff
    s_mov_b32 s58, 0x188000
    s_mov_b32 s59, 0x20000
    s_lshr_b32 s72, s2, 3
    s_lshl_b32 s72, s72, 7
    s_and_b32 s73, s2, 7
    s_lshl_b32 s74, s73, 2
    s_add_u32 s72, s72, s74
    v_lshlrev_b32 v252, 12, v0
    v_add_u32 v252, s72, v252
    v_mov_b32 v254, 0x80000000
    v_cmp_gt_u32 vcc, 8, v0
    s_nop 1
    v_cndmask_b32 v252, v254, v252, vcc
    v_and_b32 v254, 63, v0
    v_min_u32 v254, 55, v254
    v_lshrrev_b32 v253, 1, v254
    v_lshlrev_b32 v253, 7, v253
    v_and_b32 v254, 1, v254
    v_lshl_add_u32 v253, v254, 4, v253
    s_lshl_b32 s73, s73, 12
    v_add_u32 v253, s73, v253
    v_readfirstlane_b32 s88, v0
    s_nop 0
    s_lshr_b32 s88, s88, 6
    v_mov_b32 v118, 0x3f803f80
    v_mov_b32 v116, 0
    v_mov_b32 v117, 0
    s_waitcnt vmcnt(16)
    v_dot2_f32_bf16 v116, v36, v118, v116
    v_dot2_f32_bf16 v117, v36, v36, v117
    v_dot2_f32_bf16 v116, v37, v118, v116
    v_dot2_f32_bf16 v117, v37, v37, v117
    v_dot2_f32_bf16 v116, v38, v118, v116
    v_dot2_f32_bf16 v117, v38, v38, v117
    v_dot2_f32_bf16 v116, v39, v118, v116
    v_dot2_f32_bf16 v117, v39, v39, v117
    s_waitcnt vmcnt(15)
    v_dot2_f32_bf16 v116, v40, v118, v116
    v_dot2_f32_bf16 v117, v40, v40, v117
    v_dot2_f32_bf16 v116, v41, v118, v116
    v_dot2_f32_bf16 v117, v41, v41, v117
    v_dot2_f32_bf16 v116, v42, v118, v116
    v_dot2_f32_bf16 v117, v42, v42, v117
    v_dot2_f32_bf16 v116, v43, v118, v116
    v_dot2_f32_bf16 v117, v43, v43, v117
    s_waitcnt vmcnt(14)
    v_dot2_f32_bf16 v116, v44, v118, v116
    v_dot2_f32_bf16 v117, v44, v44, v117
    v_dot2_f32_bf16 v116, v45, v118, v116
    v_dot2_f32_bf16 v117, v45, v45, v117
    v_dot2_f32_bf16 v116, v46, v118, v116
    v_dot2_f32_bf16 v117, v46, v46, v117
    v_dot2_f32_bf16 v116, v47, v118, v116
    v_dot2_f32_bf16 v117, v47, v47, v117
    s_waitcnt vmcnt(13)
    v_dot2_f32_bf16 v116, v48, v118, v116
    v_dot2_f32_bf16 v117, v48, v48, v117
    v_dot2_f32_bf16 v116, v49, v118, v116
    v_dot2_f32_bf16 v117, v49, v49, v117
    v_dot2_f32_bf16 v116, v50, v118, v116
    v_dot2_f32_bf16 v117, v50, v50, v117
    v_dot2_f32_bf16 v116, v51, v118, v116
    v_dot2_f32_bf16 v117, v51, v51, v117
    s_nop 1
    v_add_f32_dpp v116, v116, v116 row_ror:8 row_mask:0xf bank_mask:0xf
    v_add_f32_dpp v117, v117, v117 row_ror:8 row_mask:0xf bank_mask:0xf
    s_nop 0
    v_add_f32_dpp v116, v116, v116 row_ror:4 row_mask:0xf bank_mask:0xf
    v_add_f32_dpp v117, v117, v117 row_ror:4 row_mask:0xf bank_mask:0xf
    s_nop 0
    v_add_f32_dpp v116, v116, v116 row_ror:2 row_mask:0xf bank_mask:0xf
    v_add_f32_dpp v117, v117, v117 row_ror:2 row_mask:0xf bank_mask:0xf
    s_nop 0
    v_add_f32_dpp v116, v116, v116 row_ror:1 row_mask:0xf bank_mask:0xf
    v_add_f32_dpp v117, v117, v117 row_ror:1 row_mask:0xf bank_mask:0xf
    v_mul_f32 v116, 0x3b124925, v116
    v_mul_f32 v117, 0x3b124925, v117
    v_fma_f32 v117, -v116, v116, v117
    v_max_f32 v117, 0, v117
    v_add_f32 v117, 0x3727c5ac, v117
    v_rsq_f32 v120, v117
    s_nop 0
    v_mul_f32_e64 v121, -v116, v120
    buffer_store_dwordx2 v[120:121], v101, s[44:47], 0 offen sc1
    v_mov_b32 v124, 0x3f803f80
    v_mov_b32 v122, 0
    v_mov_b32 v123, 0
    s_waitcnt vmcnt(13)
    v_dot2_f32_bf16 v122, v52, v124, v122
    v_dot2_f32_bf16 v123, v52, v52, v123
    v_dot2_f32_bf16 v122, v53, v124, v122
    v_dot2_f32_bf16 v123, v53, v53, v123
    v_dot2_f32_bf16 v122, v54, v124, v122
    v_dot2_f32_bf16 v123, v54, v54, v123
    v_dot2_f32_bf16 v122, v55, v124, v122
    v_dot2_f32_bf16 v123, v55, v55, v123
    s_waitcnt vmcnt(12)
    v_dot2_f32_bf16 v122, v56, v124, v122
    v_dot2_f32_bf16 v123, v56, v56, v123
    v_dot2_f32_bf16 v122, v57, v124, v122
    v_dot2_f32_bf16 v123, v57, v57, v123
    v_dot2_f32_bf16 v122, v58, v124, v122
    v_dot2_f32_bf16 v123, v58, v58, v123
    v_dot2_f32_bf16 v122, v59, v124, v122
    v_dot2_f32_bf16 v123, v59, v59, v123
    s_waitcnt vmcnt(11)
    v_dot2_f32_bf16 v122, v60, v124, v122
    v_dot2_f32_bf16 v123, v60, v60, v123
    v_dot2_f32_bf16 v122, v61, v124, v122
    v_dot2_f32_bf16 v123, v61, v61, v123
    v_dot2_f32_bf16 v122, v62, v124, v122
    v_dot2_f32_bf16 v123, v62, v62, v123
    v_dot2_f32_bf16 v122, v63, v124, v122
    v_dot2_f32_bf16 v123, v63, v63, v123
    s_waitcnt vmcnt(10)
    v_dot2_f32_bf16 v122, v64, v124, v122
    v_dot2_f32_bf16 v123, v64, v64, v123
    v_dot2_f32_bf16 v122, v65, v124, v122
    v_dot2_f32_bf16 v123, v65, v65, v123
    v_dot2_f32_bf16 v122, v66, v124, v122
    v_dot2_f32_bf16 v123, v66, v66, v123
    v_dot2_f32_bf16 v122, v67, v124, v122
    v_dot2_f32_bf16 v123, v67, v67, v123
    s_nop 1
    v_add_f32_dpp v122, v122, v122 row_ror:8 row_mask:0xf bank_mask:0xf
    v_add_f32_dpp v123, v123, v123 row_ror:8 row_mask:0xf bank_mask:0xf
    s_nop 0
    v_add_f32_dpp v122, v122, v122 row_ror:4 row_mask:0xf bank_mask:0xf
    v_add_f32_dpp v123, v123, v123 row_ror:4 row_mask:0xf bank_mask:0xf
    s_nop 0
    v_add_f32_dpp v122, v122, v122 row_ror:2 row_mask:0xf bank_mask:0xf
    v_add_f32_dpp v123, v123, v123 row_ror:2 row_mask:0xf bank_mask:0xf
    s_nop 0
    v_add_f32_dpp v122, v122, v122 row_ror:1 row_mask:0xf bank_mask:0xf
    v_add_f32_dpp v123, v123, v123 row_ror:1 row_mask:0xf bank_mask:0xf
    v_mul_f32 v122, 0x3b124925, v122
    v_mul_f32 v123, 0x3b124925, v123
    v_fma_f32 v123, -v122, v122, v123
    v_max_f32 v123, 0, v123
    v_add_f32 v123, 0x3727c5ac, v123
    v_rsq_f32 v126, v123
    s_nop 0
    v_mul_f32_e64 v127, -v122, v126
    buffer_store_dwordx2 v[126:127], v105, s[44:47], 0 offen sc1
    v_mov_b32 v130, 0x3f803f80
    v_mov_b32 v128, 0
    v_mov_b32 v129, 0
    s_waitcnt vmcnt(10)
    v_dot2_f32_bf16 v128, v68, v130, v128
    v_dot2_f32_bf16 v129, v68, v68, v129
    v_dot2_f32_bf16 v128, v69, v130, v128
    v_dot2_f32_bf16 v129, v69, v69, v129
    v_dot2_f32_bf16 v128, v70, v130, v128
    v_dot2_f32_bf16 v129, v70, v70, v129
    v_dot2_f32_bf16 v128, v71, v130, v128
    v_dot2_f32_bf16 v129, v71, v71, v129
    s_waitcnt vmcnt(9)
    v_dot2_f32_bf16 v128, v72, v130, v128
    v_dot2_f32_bf16 v129, v72, v72, v129
    v_dot2_f32_bf16 v128, v73, v130, v128
    v_dot2_f32_bf16 v129, v73, v73, v129
    v_dot2_f32_bf16 v128, v74, v130, v128
    v_dot2_f32_bf16 v129, v74, v74, v129
    v_dot2_f32_bf16 v128, v75, v130, v128
    v_dot2_f32_bf16 v129, v75, v75, v129
    s_waitcnt vmcnt(8)
    v_dot2_f32_bf16 v128, v76, v130, v128
    v_dot2_f32_bf16 v129, v76, v76, v129
    v_dot2_f32_bf16 v128, v77, v130, v128
    v_dot2_f32_bf16 v129, v77, v77, v129
    v_dot2_f32_bf16 v128, v78, v130, v128
    v_dot2_f32_bf16 v129, v78, v78, v129
    v_dot2_f32_bf16 v128, v79, v130, v128
    v_dot2_f32_bf16 v129, v79, v79, v129
    s_waitcnt vmcnt(7)
    v_dot2_f32_bf16 v128, v80, v130, v128
    v_dot2_f32_bf16 v129, v80, v80, v129
    v_dot2_f32_bf16 v128, v81, v130, v128
    v_dot2_f32_bf16 v129, v81, v81, v129
    v_dot2_f32_bf16 v128, v82, v130, v128
    v_dot2_f32_bf16 v129, v82, v82, v129
    v_dot2_f32_bf16 v128, v83, v130, v128
    v_dot2_f32_bf16 v129, v83, v83, v129
    s_nop 1
    v_add_f32_dpp v128, v128, v128 row_ror:8 row_mask:0xf bank_mask:0xf
    v_add_f32_dpp v129, v129, v129 row_ror:8 row_mask:0xf bank_mask:0xf
    s_nop 0
    v_add_f32_dpp v128, v128, v128 row_ror:4 row_mask:0xf bank_mask:0xf
    v_add_f32_dpp v129, v129, v129 row_ror:4 row_mask:0xf bank_mask:0xf
    s_nop 0
    v_add_f32_dpp v128, v128, v128 row_ror:2 row_mask:0xf bank_mask:0xf
    v_add_f32_dpp v129, v129, v129 row_ror:2 row_mask:0xf bank_mask:0xf
    s_nop 0
    v_add_f32_dpp v128, v128, v128 row_ror:1 row_mask:0xf bank_mask:0xf
    v_add_f32_dpp v129, v129, v129 row_ror:1 row_mask:0xf bank_mask:0xf
    v_mul_f32 v128, 0x3b124925, v128
    v_mul_f32 v129, 0x3b124925, v129
    v_fma_f32 v129, -v128, v128, v129
    v_max_f32 v129, 0, v129
    v_add_f32 v129, 0x3727c5ac, v129
    v_rsq_f32 v132, v129
    s_nop 0
    v_mul_f32_e64 v133, -v128, v132
    buffer_store_dwordx2 v[132:133], v109, s[44:47], 0 offen sc1
    v_mov_b32 v136, 0x3f803f80
    v_mov_b32 v134, 0
    v_mov_b32 v135, 0
    s_waitcnt vmcnt(7)
    v_dot2_f32_bf16 v134, v84, v136, v134
    v_dot2_f32_bf16 v135, v84, v84, v135
    v_dot2_f32_bf16 v134, v85, v136, v134
    v_dot2_f32_bf16 v135, v85, v85, v135
    v_dot2_f32_bf16 v134, v86, v136, v134
    v_dot2_f32_bf16 v135, v86, v86, v135
    v_dot2_f32_bf16 v134, v87, v136, v134
    v_dot2_f32_bf16 v135, v87, v87, v135
    s_waitcnt vmcnt(6)
    v_dot2_f32_bf16 v134, v88, v136, v134
    v_dot2_f32_bf16 v135, v88, v88, v135
    v_dot2_f32_bf16 v134, v89, v136, v134
    v_dot2_f32_bf16 v135, v89, v89, v135
    v_dot2_f32_bf16 v134, v90, v136, v134
    v_dot2_f32_bf16 v135, v90, v90, v135
    v_dot2_f32_bf16 v134, v91, v136, v134
    v_dot2_f32_bf16 v135, v91, v91, v135
    s_waitcnt vmcnt(5)
    v_dot2_f32_bf16 v134, v92, v136, v134
    v_dot2_f32_bf16 v135, v92, v92, v135
    v_dot2_f32_bf16 v134, v93, v136, v134
    v_dot2_f32_bf16 v135, v93, v93, v135
    v_dot2_f32_bf16 v134, v94, v136, v134
    v_dot2_f32_bf16 v135, v94, v94, v135
    v_dot2_f32_bf16 v134, v95, v136, v134
    v_dot2_f32_bf16 v135, v95, v95, v135
    s_waitcnt vmcnt(4)
    v_dot2_f32_bf16 v134, v96, v136, v134
    v_dot2_f32_bf16 v135, v96, v96, v135
    v_dot2_f32_bf16 v134, v97, v136, v134
    v_dot2_f32_bf16 v135, v97, v97, v135
    v_dot2_f32_bf16 v134, v98, v136, v134
    v_dot2_f32_bf16 v135, v98, v98, v135
    v_dot2_f32_bf16 v134, v99, v136, v134
    v_dot2_f32_bf16 v135, v99, v99, v135
    s_nop 1
    v_add_f32_dpp v134, v134, v134 row_ror:8 row_mask:0xf bank_mask:0xf
    v_add_f32_dpp v135, v135, v135 row_ror:8 row_mask:0xf bank_mask:0xf
    s_nop 0
    v_add_f32_dpp v134, v134, v134 row_ror:4 row_mask:0xf bank_mask:0xf
    v_add_f32_dpp v135, v135, v135 row_ror:4 row_mask:0xf bank_mask:0xf
    s_nop 0
    v_add_f32_dpp v134, v134, v134 row_ror:2 row_mask:0xf bank_mask:0xf
    v_add_f32_dpp v135, v135, v135 row_ror:2 row_mask:0xf bank_mask:0xf
    s_nop 0
    v_add_f32_dpp v134, v134, v134 row_ror:1 row_mask:0xf bank_mask:0xf
    v_add_f32_dpp v135, v135, v135 row_ror:1 row_mask:0xf bank_mask:0xf
    v_mul_f32 v134, 0x3b124925, v134
    v_mul_f32 v135, 0x3b124925, v135
    v_fma_f32 v135, -v134, v134, v135
    v_max_f32 v135, 0, v135
    v_add_f32 v135, 0x3727c5ac, v135
    v_rsq_f32 v138, v135
    s_nop 0
    v_mul_f32_e64 v139, -v134, v138
    buffer_store_dwordx2 v[138:139], v113, s[44:47], 0 offen sc1
    s_waitcnt vmcnt(4)
    v_readfirstlane_b32 s93, v8
    s_nop 0
    s_add_u32 s93, s93, 0x9e3779b9
    s_waitcnt vmcnt(0)
    s_barrier
    s_mov_b32 s100, 0x1000
    v_mov_b32 v4, s93
    buffer_store_dword v4, v252, s[44:47], s100 offen sc1
    s_sub_u32 s72, s2, 224
    s_cmp_ge_u32 s72, 28
    s_cbranch_scc1 L_cs_done
    s_cmp_ge_u32 s72, 14
    s_cselect_b32 s64, s52, s48
    s_cselect_b32 s65, s53, s49
    s_cselect_b32 s74, 14, 0
    s_cselect_b32 s75, 1792, 0
    s_mov_b32 s66, 1605632
    s_mov_b32 s67, 0x20000
    s_sub_u32 s72, s72, s74
    v_lshrrev_b32 v16, 4, v0
    v_mul_u32_u24 v15, 3584, v16
    v_and_b32 v16, 15, v0
    v_lshl_add_u32 v15, v16, 4, v15
    s_lshl_b32 s73, s72, 8
    v_add_u32 v15, s73, v15
    s_mov_b32 s73, 0
    buffer_load_dwordx4 v[20:23], v15, s[64:67], s73 offen
    s_mov_b32 s73, 57344
    buffer_load_dwordx4 v[24:27], v15, s[64:67], s73 offen
    s_mov_b32 s73, 114688
    buffer_load_dwordx4 v[28:31], v15, s[64:67], s73 offen
    s_mov_b32 s73, 172032
    buffer_load_dwordx4 v[32:35], v15, s[64:67], s73 offen
    s_mov_b32 s73, 229376
    buffer_load_dwordx4 v[36:39], v15, s[64:67], s73 offen
    s_mov_b32 s73, 286720
    buffer_load_dwordx4 v[40:43], v15, s[64:67], s73 offen
    s_mov_b32 s73, 344064
    buffer_load_dwordx4 v[44:47], v15, s[64:67], s73 offen
    s_mov_b32 s73, 401408
    buffer_load_dwordx4 v[48:51], v15, s[64:67], s73 offen
    s_mov_b32 s73, 458752
    buffer_load_dwordx4 v[52:55], v15, s[64:67], s73 offen
    s_mov_b32 s73, 516096
    buffer_load_dwordx4 v[56:59], v15, s[64:67], s73 offen
    s_mov_b32 s73, 573440
    buffer_load_dwordx4 v[60:63], v15, s[64:67], s73 offen
    s_mov_b32 s73, 630784
    buffer_load_dwordx4 v[64:67], v15, s[64:67], s73 offen
    s_mov_b32 s73, 688128
    buffer_load_dwordx4 v[68:71], v15, s[64:67], s73 offen
    s_mov_b32 s73, 745472
    buffer_load_dwordx4 v[72:75], v15, s[64:67], s73 offen
    s_mov_b32 s73, 802816
    buffer_load_dwordx4 v[76:79], v15, s[64:67], s73 offen
    s_mov_b32 s73, 860160
    buffer_load_dwordx4 v[80:83], v15, s[64:67], s73 offen
    s_mov_b32 s73, 917504
    buffer_load_dwordx4 v[84:87], v15, s[64:67], s73 offen
    s_mov_b32 s73, 974848
    buffer_load_dwordx4 v[88:91], v15, s[64:67], s73 offen
    s_mov_b32 s73, 1032192
    buffer_load_dwordx4 v[92:95], v15, s[64:67], s73 offen
    s_mov_b32 s73, 1089536
    buffer_load_dwordx4 v[96:99], v15, s[64:67], s73 offen
    s_mov_b32 s73, 1146880
    buffer_load_dwordx4 v[100:103], v15, s[64:67], s73 offen
    s_mov_b32 s73, 1204224
    buffer_load_dwordx4 v[104:107], v15, s[64:67], s73 offen
    s_mov_b32 s73, 1261568
    buffer_load_dwordx4 v[108:111], v15, s[64:67], s73 offen
    s_mov_b32 s73, 1318912
    buffer_load_dwordx4 v[112:115], v15, s[64:67], s73 offen
    s_mov_b32 s73, 1376256
    buffer_load_dwordx4 v[116:119], v15, s[64:67], s73 offen
    s_mov_b32 s73, 1433600
    buffer_load_dwordx4 v[120:123], v15, s[64:67], s73 offen
    s_mov_b32 s73, 1490944
    buffer_load_dwordx4 v[124:127], v15, s[64:67], s73 offen
    s_mov_b32 s73, 1548288
    buffer_load_dwordx4 v[128:131], v15, s[64:67], s73 offen
    v_mov_b32 v132, 0
    v_mov_b32 v133, 0
    v_mov_b32 v134, 0
    v_mov_b32 v135, 0
    v_mov_b32 v136, 0
    v_mov_b32 v137, 0
    v_mov_b32 v138, 0
    v_mov_b32 v139, 0
    s_waitcnt vmcnt(27)
    v_lshlrev_b32 v140, 16, v20
    v_and_b32 v141, 0xffff0000, v20
    v_pk_add_f32 v[132:133], v[132:133], v[140:141]
    v_lshlrev_b32 v140, 16, v21
    v_and_b32 v141, 0xffff0000, v21
    v_pk_add_f32 v[134:135], v[134:135], v[140:141]
    v_lshlrev_b32 v140, 16, v22
    v_and_b32 v141, 0xffff0000, v22
    v_pk_add_f32 v[136:137], v[136:137], v[140:141]
    v_lshlrev_b32 v140, 16, v23
    v_and_b32 v141, 0xffff0000, v23
    v_pk_add_f32 v[138:139], v[138:139], v[140:141]
    s_waitcnt vmcnt(26)
    v_lshlrev_b32 v140, 16, v24
    v_and_b32 v141, 0xffff0000, v24
    v_pk_add_f32 v[132:133], v[132:133], v[140:141]
    v_lshlrev_b32 v140, 16, v25
    v_and_b32 v141, 0xffff0000, v25
    v_pk_add_f32 v[134:135], v[134:135], v[140:141]
    v_lshlrev_b32 v140, 16, v26
    v_and_b32 v141, 0xffff0000, v26
    v_pk_add_f32 v[136:137], v[136:137], v[140:141]
    v_lshlrev_b32 v140, 16, v27
    v_and_b32 v141, 0xffff0000, v27
    v_pk_add_f32 v[138:139], v[138:139], v[140:141]
    s_waitcnt vmcnt(25)
    v_lshlrev_b32 v140, 16, v28
    v_and_b32 v141, 0xffff0000, v28
    v_pk_add_f32 v[132:133], v[132:133], v[140:141]
    v_lshlrev_b32 v140, 16, v29
    v_and_b32 v141, 0xffff0000, v29
    v_pk_add_f32 v[134:135], v[134:135], v[140:141]
    v_lshlrev_b32 v140, 16, v30
    v_and_b32 v141, 0xffff0000, v30
    v_pk_add_f32 v[136:137], v[136:137], v[140:141]
    v_lshlrev_b32 v140, 16, v31
    v_and_b32 v141, 0xffff0000, v31
    v_pk_add_f32 v[138:139], v[138:139], v[140:141]
    s_waitcnt vmcnt(24)
    v_lshlrev_b32 v140, 16, v32
    v_and_b32 v141, 0xffff0000, v32
    v_pk_add_f32 v[132:133], v[132:133], v[140:141]
    v_lshlrev_b32 v140, 16, v33
    v_and_b32 v141, 0xffff0000, v33
    v_pk_add_f32 v[134:135], v[134:135], v[140:141]
    v_lshlrev_b32 v140, 16, v34
    v_and_b32 v141, 0xffff0000, v34
    v_pk_add_f32 v[136:137], v[136:137], v[140:141]
    v_lshlrev_b32 v140, 16, v35
    v_and_b32 v141, 0xffff0000, v35
    v_pk_add_f32 v[138:139], v[138:139], v[140:141]
    s_waitcnt vmcnt(23)
    v_lshlrev_b32 v140, 16, v36
    v_and_b32 v141, 0xffff0000, v36
    v_pk_add_f32 v[132:133], v[132:133], v[140:141]
    v_lshlrev_b32 v140, 16, v37
    v_and_b32 v141, 0xffff0000, v37
    v_pk_add_f32 v[134:135], v[134:135], v[140:141]
    v_lshlrev_b32 v140, 16, v38
    v_and_b32 v141, 0xffff0000, v38
    v_pk_add_f32 v[136:137], v[136:137], v[140:141]
    v_lshlrev_b32 v140, 16, v39
    v_and_b32 v141, 0xffff0000, v39
    v_pk_add_f32 v[138:139], v[138:139], v[140:141]
    s_waitcnt vmcnt(22)
    v_lshlrev_b32 v140, 16, v40
    v_and_b32 v141, 0xffff0000, v40
    v_pk_add_f32 v[132:133], v[132:133], v[140:141]
    v_lshlrev_b32 v140, 16, v41
    v_and_b32 v141, 0xffff0000, v41
    v_pk_add_f32 v[134:135], v[134:135], v[140:141]
    v_lshlrev_b32 v140, 16, v42
    v_and_b32 v141, 0xffff0000, v42
    v_pk_add_f32 v[136:137], v[136:137], v[140:141]
    v_lshlrev_b32 v140, 16, v43
    v_and_b32 v141, 0xffff0000, v43
    v_pk_add_f32 v[138:139], v[138:139], v[140:141]
    s_waitcnt vmcnt(21)
    v_lshlrev_b32 v140, 16, v44
    v_and_b32 v141, 0xffff0000, v44
    v_pk_add_f32 v[132:133], v[132:133], v[140:141]
    v_lshlrev_b32 v140, 16, v45
    v_and_b32 v141, 0xffff0000, v45
    v_pk_add_f32 v[134:135], v[134:135], v[140:141]
    v_lshlrev_b32 v140, 16, v46
    v_and_b32 v141, 0xffff0000, v46
    v_pk_add_f32 v[136:137], v[136:137], v[140:141]
    v_lshlrev_b32 v140, 16, v47
    v_and_b32 v141, 0xffff0000, v47
    v_pk_add_f32 v[138:139], v[138:139], v[140:141]
    s_waitcnt vmcnt(20)
    v_lshlrev_b32 v140, 16, v48
    v_and_b32 v141, 0xffff0000, v48
    v_pk_add_f32 v[132:133], v[132:133], v[140:141]
    v_lshlrev_b32 v140, 16, v49
    v_and_b32 v141, 0xffff0000, v49
    v_pk_add_f32 v[134:135], v[134:135], v[140:141]
    v_lshlrev_b32 v140, 16, v50
    v_and_b32 v141, 0xffff0000, v50
    v_pk_add_f32 v[136:137], v[136:137], v[140:141]
    v_lshlrev_b32 v140, 16, v51
    v_and_b32 v141, 0xffff0000, v51
    v_pk_add_f32 v[138:139], v[138:139], v[140:141]
    s_waitcnt vmcnt(19)
    v_lshlrev_b32 v140, 16, v52
    v_and_b32 v141, 0xffff0000, v52
    v_pk_add_f32 v[132:133], v[132:133], v[140:141]
    v_lshlrev_b32 v140, 16, v53
    v_and_b32 v141, 0xffff0000, v53
    v_pk_add_f32 v[134:135], v[134:135], v[140:141]
    v_lshlrev_b32 v140, 16, v54
    v_and_b32 v141, 0xffff0000, v54
    v_pk_add_f32 v[136:137], v[136:137], v[140:141]
    v_lshlrev_b32 v140, 16, v55
    v_and_b32 v141, 0xffff0000, v55
    v_pk_add_f32 v[138:139], v[138:139], v[140:141]
    s_waitcnt vmcnt(18)
    v_lshlrev_b32 v140, 16, v56
    v_and_b32 v141, 0xffff0000, v56
    v_pk_add_f32 v[132:133], v[132:133], v[140:141]
    v_lshlrev_b32 v140, 16, v57
    v_and_b32 v141, 0xffff0000, v57
    v_pk_add_f32 v[134:135], v[134:135], v[140:141]
    v_lshlrev_b32 v140, 16, v58
    v_and_b32 v141, 0xffff0000, v58
    v_pk_add_f32 v[136:137], v[136:137], v[140:141]
    v_lshlrev_b32 v140, 16, v59
    v_and_b32 v141, 0xffff0000, v59
    v_pk_add_f32 v[138:139], v[138:139], v[140:141]
    s_waitcnt vmcnt(17)
    v_lshlrev_b32 v140, 16, v60
    v_and_b32 v141, 0xffff0000, v60
    v_pk_add_f32 v[132:133], v[132:133], v[140:141]
    v_lshlrev_b32 v140, 16, v61
    v_and_b32 v141, 0xffff0000, v61
    v_pk_add_f32 v[134:135], v[134:135], v[140:141]
    v_lshlrev_b32 v140, 16, v62
    v_and_b32 v141, 0xffff0000, v62
    v_pk_add_f32 v[136:137], v[136:137], v[140:141]
    v_lshlrev_b32 v140, 16, v63
    v_and_b32 v141, 0xffff0000, v63
    v_pk_add_f32 v[138:139], v[138:139], v[140:141]
    s_waitcnt vmcnt(16)
    v_lshlrev_b32 v140, 16, v64
    v_and_b32 v141, 0xffff0000, v64
    v_pk_add_f32 v[132:133], v[132:133], v[140:141]
    v_lshlrev_b32 v140, 16, v65
    v_and_b32 v141, 0xffff0000, v65
    v_pk_add_f32 v[134:135], v[134:135], v[140:141]
    v_lshlrev_b32 v140, 16, v66
    v_and_b32 v141, 0xffff0000, v66
    v_pk_add_f32 v[136:137], v[136:137], v[140:141]
    v_lshlrev_b32 v140, 16, v67
    v_and_b32 v141, 0xffff0000, v67
    v_pk_add_f32 v[138:139], v[138:139], v[140:141]
    s_waitcnt vmcnt(15)
    v_lshlrev_b32 v140, 16, v68
    v_and_b32 v141, 0xffff0000, v68
    v_pk_add_f32 v[132:133], v[132:133], v[140:141]
    v_lshlrev_b32 v140, 16, v69
    v_and_b32 v141, 0xffff0000, v69
    v_pk_add_f32 v[134:135], v[134:135], v[140:141]
    v_lshlrev_b32 v140, 16, v70
    v_and_b32 v141, 0xffff0000, v70
    v_pk_add_f32 v[136:137], v[136:137], v[140:141]
    v_lshlrev_b32 v140, 16, v71
    v_and_b32 v141, 0xffff0000, v71
    v_pk_add_f32 v[138:139], v[138:139], v[140:141]
    s_waitcnt vmcnt(14)
    v_lshlrev_b32 v140, 16, v72
    v_and_b32 v141, 0xffff0000, v72
    v_pk_add_f32 v[132:133], v[132:133], v[140:141]
    v_lshlrev_b32 v140, 16, v73
    v_and_b32 v141, 0xffff0000, v73
    v_pk_add_f32 v[134:135], v[134:135], v[140:141]
    v_lshlrev_b32 v140, 16, v74
    v_and_b32 v141, 0xffff0000, v74
    v_pk_add_f32 v[136:137], v[136:137], v[140:141]
    v_lshlrev_b32 v140, 16, v75
    v_and_b32 v141, 0xffff0000, v75
    v_pk_add_f32 v[138:139], v[138:139], v[140:141]
    s_waitcnt vmcnt(13)
    v_lshlrev_b32 v140, 16, v76
    v_and_b32 v141, 0xffff0000, v76
    v_pk_add_f32 v[132:133], v[132:133], v[140:141]
    v_lshlrev_b32 v140, 16, v77
    v_and_b32 v141, 0xffff0000, v77
    v_pk_add_f32 v[134:135], v[134:135], v[140:141]
    v_lshlrev_b32 v140, 16, v78
    v_and_b32 v141, 0xffff0000, v78
    v_pk_add_f32 v[136:137], v[136:137], v[140:141]
    v_lshlrev_b32 v140, 16, v79
    v_and_b32 v141, 0xffff0000, v79
    v_pk_add_f32 v[138:139], v[138:139], v[140:141]
    s_waitcnt vmcnt(12)
    v_lshlrev_b32 v140, 16, v80
    v_and_b32 v141, 0xffff0000, v80
    v_pk_add_f32 v[132:133], v[132:133], v[140:141]
    v_lshlrev_b32 v140, 16, v81
    v_and_b32 v141, 0xffff0000, v81
    v_pk_add_f32 v[134:135], v[134:135], v[140:141]
    v_lshlrev_b32 v140, 16, v82
    v_and_b32 v141, 0xffff0000, v82
    v_pk_add_f32 v[136:137], v[136:137], v[140:141]
    v_lshlrev_b32 v140, 16, v83
    v_and_b32 v141, 0xffff0000, v83
    v_pk_add_f32 v[138:139], v[138:139], v[140:141]
    s_waitcnt vmcnt(11)
    v_lshlrev_b32 v140, 16, v84
    v_and_b32 v141, 0xffff0000, v84
    v_pk_add_f32 v[132:133], v[132:133], v[140:141]
    v_lshlrev_b32 v140, 16, v85
    v_and_b32 v141, 0xffff0000, v85
    v_pk_add_f32 v[134:135], v[134:135], v[140:141]
    v_lshlrev_b32 v140, 16, v86
    v_and_b32 v141, 0xffff0000, v86
    v_pk_add_f32 v[136:137], v[136:137], v[140:141]
    v_lshlrev_b32 v140, 16, v87
    v_and_b32 v141, 0xffff0000, v87
    v_pk_add_f32 v[138:139], v[138:139], v[140:141]
    s_waitcnt vmcnt(10)
    v_lshlrev_b32 v140, 16, v88
    v_and_b32 v141, 0xffff0000, v88
    v_pk_add_f32 v[132:133], v[132:133], v[140:141]
    v_lshlrev_b32 v140, 16, v89
    v_and_b32 v141, 0xffff0000, v89
    v_pk_add_f32 v[134:135], v[134:135], v[140:141]
    v_lshlrev_b32 v140, 16, v90
    v_and_b32 v141, 0xffff0000, v90
    v_pk_add_f32 v[136:137], v[136:137], v[140:141]
    v_lshlrev_b32 v140, 16, v91
    v_and_b32 v141, 0xffff0000, v91
    v_pk_add_f32 v[138:139], v[138:139], v[140:141]
    s_waitcnt vmcnt(9)
    v_lshlrev_b32 v140, 16, v92
    v_and_b32 v141, 0xffff0000, v92
    v_pk_add_f32 v[132:133], v[132:133], v[140:141]
    v_lshlrev_b32 v140, 16, v93
    v_and_b32 v141, 0xffff0000, v93
    v_pk_add_f32 v[134:135], v[134:135], v[140:141]
    v_lshlrev_b32 v140, 16, v94
    v_and_b32 v141, 0xffff0000, v94
    v_pk_add_f32 v[136:137], v[136:137], v[140:141]
    v_lshlrev_b32 v140, 16, v95
    v_and_b32 v141, 0xffff0000, v95
    v_pk_add_f32 v[138:139], v[138:139], v[140:141]
    s_waitcnt vmcnt(8)
    v_lshlrev_b32 v140, 16, v96
    v_and_b32 v141, 0xffff0000, v96
    v_pk_add_f32 v[132:133], v[132:133], v[140:141]
    v_lshlrev_b32 v140, 16, v97
    v_and_b32 v141, 0xffff0000, v97
    v_pk_add_f32 v[134:135], v[134:135], v[140:141]
    v_lshlrev_b32 v140, 16, v98
    v_and_b32 v141, 0xffff0000, v98
    v_pk_add_f32 v[136:137], v[136:137], v[140:141]
    v_lshlrev_b32 v140, 16, v99
    v_and_b32 v141, 0xffff0000, v99
    v_pk_add_f32 v[138:139], v[138:139], v[140:141]
    s_waitcnt vmcnt(7)
    v_lshlrev_b32 v140, 16, v100
    v_and_b32 v141, 0xffff0000, v100
    v_pk_add_f32 v[132:133], v[132:133], v[140:141]
    v_lshlrev_b32 v140, 16, v101
    v_and_b32 v141, 0xffff0000, v101
    v_pk_add_f32 v[134:135], v[134:135], v[140:141]
    v_lshlrev_b32 v140, 16, v102
    v_and_b32 v141, 0xffff0000, v102
    v_pk_add_f32 v[136:137], v[136:137], v[140:141]
    v_lshlrev_b32 v140, 16, v103
    v_and_b32 v141, 0xffff0000, v103
    v_pk_add_f32 v[138:139], v[138:139], v[140:141]
    s_waitcnt vmcnt(6)
    v_lshlrev_b32 v140, 16, v104
    v_and_b32 v141, 0xffff0000, v104
    v_pk_add_f32 v[132:133], v[132:133], v[140:141]
    v_lshlrev_b32 v140, 16, v105
    v_and_b32 v141, 0xffff0000, v105
    v_pk_add_f32 v[134:135], v[134:135], v[140:141]
    v_lshlrev_b32 v140, 16, v106
    v_and_b32 v141, 0xffff0000, v106
    v_pk_add_f32 v[136:137], v[136:137], v[140:141]
    v_lshlrev_b32 v140, 16, v107
    v_and_b32 v141, 0xffff0000, v107
    v_pk_add_f32 v[138:139], v[138:139], v[140:141]
    s_waitcnt vmcnt(5)
    v_lshlrev_b32 v140, 16, v108
    v_and_b32 v141, 0xffff0000, v108
    v_pk_add_f32 v[132:133], v[132:133], v[140:141]
    v_lshlrev_b32 v140, 16, v109
    v_and_b32 v141, 0xffff0000, v109
    v_pk_add_f32 v[134:135], v[134:135], v[140:141]
    v_lshlrev_b32 v140, 16, v110
    v_and_b32 v141, 0xffff0000, v110
    v_pk_add_f32 v[136:137], v[136:137], v[140:141]
    v_lshlrev_b32 v140, 16, v111
    v_and_b32 v141, 0xffff0000, v111
    v_pk_add_f32 v[138:139], v[138:139], v[140:141]
    s_waitcnt vmcnt(4)
    v_lshlrev_b32 v140, 16, v112
    v_and_b32 v141, 0xffff0000, v112
    v_pk_add_f32 v[132:133], v[132:133], v[140:141]
    v_lshlrev_b32 v140, 16, v113
    v_and_b32 v141, 0xffff0000, v113
    v_pk_add_f32 v[134:135], v[134:135], v[140:141]
    v_lshlrev_b32 v140, 16, v114
    v_and_b32 v141, 0xffff0000, v114
    v_pk_add_f32 v[136:137], v[136:137], v[140:141]
    v_lshlrev_b32 v140, 16, v115
    v_and_b32 v141, 0xffff0000, v115
    v_pk_add_f32 v[138:139], v[138:139], v[140:141]
    s_waitcnt vmcnt(3)
    v_lshlrev_b32 v140, 16, v116
    v_and_b32 v141, 0xffff0000, v116
    v_pk_add_f32 v[132:133], v[132:133], v[140:141]
    v_lshlrev_b32 v140, 16, v117
    v_and_b32 v141, 0xffff0000, v117
    v_pk_add_f32 v[134:135], v[134:135], v[140:141]
    v_lshlrev_b32 v140, 16, v118
    v_and_b32 v141, 0xffff0000, v118
    v_pk_add_f32 v[136:137], v[136:137], v[140:141]
    v_lshlrev_b32 v140, 16, v119
    v_and_b32 v141, 0xffff0000, v119
    v_pk_add_f32 v[138:139], v[138:139], v[140:141]
    s_waitcnt vmcnt(2)
    v_lshlrev_b32 v140, 16, v120
    v_and_b32 v141, 0xffff0000, v120
    v_pk_add_f32 v[132:133], v[132:133], v[140:141]
    v_lshlrev_b32 v140, 16, v121
    v_and_b32 v141, 0xffff0000, v121
    v_pk_add_f32 v[134:135], v[134:135], v[140:141]
    v_lshlrev_b32 v140, 16, v122
    v_and_b32 v141, 0xffff0000, v122
    v_pk_add_f32 v[136:137], v[136:137], v[140:141]
    v_lshlrev_b32 v140, 16, v123
    v_and_b32 v141, 0xffff0000, v123
    v_pk_add_f32 v[138:139], v[138:139], v[140:141]
    s_waitcnt vmcnt(1)
    v_lshlrev_b32 v140, 16, v124
    v_and_b32 v141, 0xffff0000, v124
    v_pk_add_f32 v[132:133], v[132:133], v[140:141]
    v_lshlrev_b32 v140, 16, v125
    v_and_b32 v141, 0xffff0000, v125
    v_pk_add_f32 v[134:135], v[134:135], v[140:141]
    v_lshlrev_b32 v140, 16, v126
    v_and_b32 v141, 0xffff0000, v126
    v_pk_add_f32 v[136:137], v[136:137], v[140:141]
    v_lshlrev_b32 v140, 16, v127
    v_and_b32 v141, 0xffff0000, v127
    v_pk_add_f32 v[138:139], v[138:139], v[140:141]
    s_waitcnt vmcnt(0)
    v_lshlrev_b32 v140, 16, v128
    v_and_b32 v141, 0xffff0000, v128
    v_pk_add_f32 v[132:133], v[132:133], v[140:141]
    v_lshlrev_b32 v140, 16, v129
    v_and_b32 v141, 0xffff0000, v129
    v_pk_add_f32 v[134:135], v[134:135], v[140:141]
    v_lshlrev_b32 v140, 16, v130
    v_and_b32 v141, 0xffff0000, v130
    v_pk_add_f32 v[136:137], v[136:137], v[140:141]
    v_lshlrev_b32 v140, 16, v131
    v_and_b32 v141, 0xffff0000, v131
    v_pk_add_f32 v[138:139], v[138:139], v[140:141]
    v_lshrrev_b32 v16, 4, v0
    v_lshlrev_b32 v142, 9, v16
    v_and_b32 v16, 15, v0
    v_lshl_add_u32 v142, v16, 5, v142
    ds_write_b128 v142, v[132:135]
    ds_write_b128 v142, v[136:139] offset:16
    s_waitcnt lgkmcnt(0)
    s_barrier
    v_and_b32 v16, 127, v0
    v_lshlrev_b32 v143, 2, v16
    ds_read_b32 v144, v143 offset:0
    ds_read_b32 v145, v143 offset:512
    ds_read_b32 v146, v143 offset:1024
    ds_read_b32 v147, v143 offset:1536
    ds_read_b32 v148, v143 offset:2048
    ds_read_b32 v149, v143 offset:2560
    ds_read_b32 v150, v143 offset:3072
    ds_read_b32 v151, v143 offset:3584
    ds_read_b32 v152, v143 offset:4096
    ds_read_b32 v153, v143 offset:4608
    ds_read_b32 v154, v143 offset:5120
    ds_read_b32 v155, v143 offset:5632
    ds_read_b32 v156, v143 offset:6144
    ds_read_b32 v157, v143 offset:6656
    ds_read_b32 v158, v143 offset:7168
    ds_read_b32 v159, v143 offset:7680
    s_waitcnt lgkmcnt(14)
    v_add_f32 v144, v144, v145
    s_waitcnt lgkmcnt(13)
    v_add_f32 v144, v144, v146
    s_waitcnt lgkmcnt(12)
    v_add_f32 v144, v144, v147
    s_waitcnt lgkmcnt(11)
    v_add_f32 v144, v144, v148
    s_waitcnt lgkmcnt(10)
    v_add_f32 v144, v144, v149
    s_waitcnt lgkmcnt(9)
    v_add_f32 v144, v144, v150
    s_waitcnt lgkmcnt(8)
    v_add_f32 v144, v144, v151
    s_waitcnt lgkmcnt(7)
    v_add_f32 v144, v144, v152
    s_waitcnt lgkmcnt(6)
    v_add_f32 v144, v144, v153
    s_waitcnt lgkmcnt(5)
    v_add_f32 v144, v144, v154
    s_waitcnt lgkmcnt(4)
    v_add_f32 v144, v144, v155
    s_waitcnt lgkmcnt(3)
    v_add_f32 v144, v144, v156
    s_waitcnt lgkmcnt(2)
    v_add_f32 v144, v144, v157
    s_waitcnt lgkmcnt(1)
    v_add_f32 v144, v144, v158
    s_waitcnt lgkmcnt(0)
    v_add_f32 v144, v144, v159
    s_lshl_b32 s73, s72, 7
    s_add_u32 s73, s73, s75
    s_lshl_b32 s73, s73, 2
    s_add_u32 s73, s73, 0x48000
    v_mov_b32 v16, 0x80000000
    v_cmp_gt_u32 vcc, 128, v0
    s_nop 1
    v_cndmask_b32 v143, v16, v143, vcc
    buffer_store_dword v144, v143, s[44:47], s73 offen sc1
    s_waitcnt vmcnt(0)
L_cs_done:
    s_waitcnt vmcnt(0)
    s_barrier
    s_mov_b32 s100, 0x9000
    v_mov_b32 v4, s93
    buffer_store_dword v4, v252, s[44:47], s100 offen sc1
    s_sub_u32 s72, s2, 224
    s_mul_i32 s72, s72, 392
    v_add_u32 v16, s72, v0
    v_lshlrev_b32 v16, 7, v16
    v_add_u32 v17, 32768, v16
    buffer_load_dword v18, v16, s[56:59], 0 offen
    buffer_load_dword v19, v17, s[56:59], 0 offen
    v_and_b32 v25, 63, v0
    v_lshrrev_b32 v26, 3, v25
    v_lshlrev_b32 v20, 12, v26
    v_bfe_u32 v26, v25, 2, 1
    v_lshrrev_b32 v22, 4, v25
    v_xor_b32 v26, v26, v22
    v_and_b32 v26, 1, v26
    v_lshl_add_u32 v20, v26, 6, v20
    v_and_b32 v26, 3, v0
    v_lshl_add_u32 v20, v26, 4, v20
    s_sub_u32 s76, s2, 224
    s_lshl_b32 s76, s76, 7
    s_lshl_b32 s72, s88, 15
    s_add_u32 s76, s76, s72
    s_add_u32 s76, s76, 0x500000
    s_lshl_b32 s77, s88, 10
    v_bfe_u32 v26, v25, 2, 2
    v_lshlrev_b32 v21, 7, v26
    v_lshrrev_b32 v26, 5, v25
    v_lshl_add_u32 v21, v26, 10, v21
    v_bfe_u32 v26, v25, 3, 1
    v_lshl_add_u32 v21, v26, 6, v21
    v_bfe_u32 v26, v25, 4, 1
    v_lshl_add_u32 v21, v26, 5, v21
    v_and_b32 v26, 3, v25
    v_lshl_add_u32 v21, v26, 3, v21
    s_and_b32 s72, s88, 1
    s_lshl_b32 s72, s72, 6
    v_xor_b32 v21, s72, v21
    s_lshr_b32 s72, s88, 1
    s_mul_i32 s72, s72, 28672
    v_add_u32 v21, s72, v21
    v_and_b32 v25, 31, v0
    v_lshlrev_b32 v26, 3, v25
    v_add_u32 v26, 57344, v26
    s_and_b32 s72, s88, 1
    s_lshl_b32 s72, s72, 9
    v_add_u32 v23, s72, v26
    s_lshr_b32 s73, s88, 1
    s_lshl_b32 s73, s73, 8
    v_add_u32 v22, s73, v23
    s_sub_u32 s72, s2, 224
    s_lshl_b32 s72, s72, 6
    s_and_b32 s73, s88, 1
    s_lshl_b32 s73, s73, 5
    s_add_u32 s72, s72, s73
    v_add_u32 v24, s72, v25
    v_lshlrev_b32 v24, 4, v24
    v_add_u32 v24, 0x70000, v24
    v_and_b32 v25, 0xa0, v0
    v_mov_b32 v26, 0x80000000
    v_cmp_eq_u32 vcc, 0, v25
    s_nop 1
    v_cndmask_b32 v24, v26, v24, vcc
    s_waitcnt vmcnt(0)
    s_cmp_lg_u32 s88, 0
    s_cbranch_scc1 L_HB_done
    s_mov_b32 s100, 0x9000
    s_mov_b32 s101, 0
    s_waitcnt vmcnt(0)
L_HB_loop:
    buffer_load_dwordx4 v[4:7], v253, s[44:47], s100 offen sc1
    s_waitcnt vmcnt(0)
    v_xor_b32 v4, s93, v4
    v_xor_b32 v5, s93, v5
    v_xor_b32 v6, s93, v6
    v_xor_b32 v7, s93, v7
    v_or3_b32 v4, v4, v5, v6
    v_or_b32 v4, v4, v7
    v_cmp_ne_u32 vcc, 0, v4
    s_add_u32 s101, s101, 1
    s_cmp_gt_u32 s101, 400000
    s_cbranch_scc1 L_HB_done
    s_cbranch_vccnz L_HB_loop
L_HB_done:
    s_barrier
    s_add_u32 m0, s77, 0
    s_add_u32 s72, s76, 0
    buffer_load_dwordx4 v20, s[44:47], s72 offen sc1 lds
    s_add_u32 m0, s77, 4096
    s_add_u32 s72, s76, 131072
    buffer_load_dwordx4 v20, s[44:47], s72 offen sc1 lds
    s_add_u32 m0, s77, 8192
    s_add_u32 s72, s76, 262144
    buffer_load_dwordx4 v20, s[44:47], s72 offen sc1 lds
    s_add_u32 m0, s77, 12288
    s_add_u32 s72, s76, 393216
    buffer_load_dwordx4 v20, s[44:47], s72 offen sc1 lds
    s_add_u32 m0, s77, 16384
    s_add_u32 s72, s76, 524288
    buffer_load_dwordx4 v20, s[44:47], s72 offen sc1 lds
    s_add_u32 m0, s77, 20480
    s_add_u32 s72, s76, 655360
    buffer_load_dwordx4 v20, s[44:47], s72 offen sc1 lds
    s_add_u32 m0, s77, 24576
    s_add_u32 s72, s76, 786432
    buffer_load_dwordx4 v20, s[44:47], s72 offen sc1 lds
    s_add_u32 m0, s77, 28672
    s_add_u32 s72, s76, 917504
    buffer_load_dwordx4 v20, s[44:47], s72 offen sc1 lds
    s_add_u32 m0, s77, 32768
    s_add_u32 s72, s76, 1048576
    buffer_load_dwordx4 v20, s[44:47], s72 offen sc1 lds
    s_add_u32 m0, s77, 36864
    s_add_u32 s72, s76, 1179648
    buffer_load_dwordx4 v20, s[44:47], s72 offen sc1 lds
    s_add_u32 m0, s77, 40960
    s_add_u32 s72, s76, 1310720
    buffer_load_dwordx4 v20, s[44:47], s72 offen sc1 lds
    s_add_u32 m0, s77, 45056
    s_add_u32 s72, s76, 1441792
    buffer_load_dwordx4 v20, s[44:47], s72 offen sc1 lds
    s_add_u32 m0, s77, 49152
    s_add_u32 s72, s76, 1572864
    buffer_load_dwordx4 v20, s[44:47], s72 offen sc1 lds
    s_add_u32 m0, s77, 53248
    s_add_u32 s72, s76, 1703936
    buffer_load_dwordx4 v20, s[44:47], s72 offen sc1 lds
    v_mov_b32 v34, 0x3f803f80
    v_mov_b32 v28, 0
    v_mov_b32 v29, 0
    v_mov_b32 v32, 0
    v_mov_b32 v33, 0
    s_waitcnt vmcnt(0)
    s_barrier
    ds_read_b64_tr_b16 v[36:37], v21 offset:0
    ds_read_b64_tr_b16 v[38:39], v21 offset:512
    ds_read_b64_tr_b16 v[40:41], v21 offset:2048
    ds_read_b64_tr_b16 v[42:43], v21 offset:2560
    ds_read_b64_tr_b16 v[44:45], v21 offset:4096
    ds_read_b64_tr_b16 v[46:47], v21 offset:4608
    ds_read_b64_tr_b16 v[48:49], v21 offset:6144
    ds_read_b64_tr_b16 v[50:51], v21 offset:6656
    ds_read_b64_tr_b16 v[52:53], v21 offset:8192
    ds_read_b64_tr_b16 v[54:55], v21 offset:8704
    ds_read_b64_tr_b16 v[56:57], v21 offset:10240
    ds_read_b64_tr_b16 v[58:59], v21 offset:10752
    ds_read_b64_tr_b16 v[60:61], v21 offset:12288
    ds_read_b64_tr_b16 v[62:63], v21 offset:12800
    ds_read_b64_tr_b16 v[64:65], v21 offset:14336
    ds_read_b64_tr_b16 v[66:67], v21 offset:14848
    ds_read_b64_tr_b16 v[68:69], v21 offset:16384
    ds_read_b64_tr_b16 v[70:71], v21 offset:16896
    ds_read_b64_tr_b16 v[72:73], v21 offset:18432
    ds_read_b64_tr_b16 v[74:75], v21 offset:18944
    ds_read_b64_tr_b16 v[76:77], v21 offset:20480
    ds_read_b64_tr_b16 v[78:79], v21 offset:20992
    ds_read_b64_tr_b16 v[80:81], v21 offset:22528
    ds_read_b64_tr_b16 v[82:83], v21 offset:23040
    ds_read_b64_tr_b16 v[84:85], v21 offset:24576
    ds_read_b64_tr_b16 v[86:87], v21 offset:25088
    ds_read_b64_tr_b16 v[88:89], v21 offset:26624
    ds_read_b64_tr_b16 v[90:91], v21 offset:27136
    s_waitcnt lgkmcnt(15)
    v_dot2_f32_bf16 v28, v36, v34, v28
    v_dot2_f32_bf16 v29, v36, v36, v29
    v_dot2_f32_bf16 v32, v37, v34, v32
    v_dot2_f32_bf16 v33, v37, v37, v33
    v_dot2_f32_bf16 v28, v38, v34, v28
    v_dot2_f32_bf16 v29, v38, v38, v29
    v_dot2_f32_bf16 v32, v39, v34, v32
    v_dot2_f32_bf16 v33, v39, v39, v33
    v_dot2_f32_bf16 v28, v40, v34, v28
    v_dot2_f32_bf16 v29, v40, v40, v29
    v_dot2_f32_bf16 v32, v41, v34, v32
    v_dot2_f32_bf16 v33, v41, v41, v33
    v_dot2_f32_bf16 v28, v42, v34, v28
    v_dot2_f32_bf16 v29, v42, v42, v29
    v_dot2_f32_bf16 v32, v43, v34, v32
    v_dot2_f32_bf16 v33, v43, v43, v33
    v_dot2_f32_bf16 v28, v44, v34, v28
    v_dot2_f32_bf16 v29, v44, v44, v29
    v_dot2_f32_bf16 v32, v45, v34, v32
    v_dot2_f32_bf16 v33, v45, v45, v33
    v_dot2_f32_bf16 v28, v46, v34, v28
    v_dot2_f32_bf16 v29, v46, v46, v29
    v_dot2_f32_bf16 v32, v47, v34, v32
    v_dot2_f32_bf16 v33, v47, v47, v33
    v_dot2_f32_bf16 v28, v48, v34, v28
    v_dot2_f32_bf16 v29, v48, v48, v29
    v_dot2_f32_bf16 v32, v49, v34, v32
    v_dot2_f32_bf16 v33, v49, v49, v33
    v_dot2_f32_bf16 v28, v50, v34, v28
    v_dot2_f32_bf16 v29, v50, v50, v29
    v_dot2_f32_bf16 v32, v51, v34, v32
    v_dot2_f32_bf16 v33, v51, v51, v33
    v_dot2_f32_bf16 v28, v52, v34, v28
    v_dot2_f32_bf16 v29, v52, v52, v29
    v_dot2_f32_bf16 v32, v53, v34, v32
    v_dot2_f32_bf16 v33, v53, v53, v33
    v_dot2_f32_bf16 v28, v54, v34, v28
    v_dot2_f32_bf16 v29, v54, v54, v29
    v_dot2_f32_bf16 v32, v55, v34, v32
    v_dot2_f32_bf16 v33, v55, v55, v33
    v_dot2_f32_bf16 v28, v56, v34, v28
    v_dot2_f32_bf16 v29, v56, v56, v29
    v_dot2_f32_bf16 v32, v57, v34, v32
    v_dot2_f32_bf16 v33, v57, v57, v33
    v_dot2_f32_bf16 v28, v58, v34, v28
    v_dot2_f32_bf16 v29, v58, v58, v29
    v_dot2_f32_bf16 v32, v59, v34, v32
    v_dot2_f32_bf16 v33, v59, v59, v33
    v_dot2_f32_bf16 v28, v60, v34, v28
    v_dot2_f32_bf16 v29, v60, v60, v29
    v_dot2_f32_bf16 v32, v61, v34, v32
    v_dot2_f32_bf16 v33, v61, v61, v33
    s_waitcnt lgkmcnt(14)
    v_dot2_f32_bf16 v28, v62, v34, v28
    v_dot2_f32_bf16 v29, v62, v62, v29
    v_dot2_f32_bf16 v32, v63, v34, v32
    v_dot2_f32_bf16 v33, v63, v63, v33
    s_waitcnt lgkmcnt(13)
    v_dot2_f32_bf16 v28, v64, v34, v28
    v_dot2_f32_bf16 v29, v64, v64, v29
    v_dot2_f32_bf16 v32, v65, v34, v32
    v_dot2_f32_bf16 v33, v65, v65, v33
    s_waitcnt lgkmcnt(12)
    v_dot2_f32_bf16 v28, v66, v34, v28
    v_dot2_f32_bf16 v29, v66, v66, v29
    v_dot2_f32_bf16 v32, v67, v34, v32
    v_dot2_f32_bf16 v33, v67, v67, v33
    s_waitcnt lgkmcnt(11)
    v_dot2_f32_bf16 v28, v68, v34, v28
    v_dot2_f32_bf16 v29, v68, v68, v29
    v_dot2_f32_bf16 v32, v69, v34, v32
    v_dot2_f32_bf16 v33, v69, v69, v33
    s_waitcnt lgkmcnt(10)
    v_dot2_f32_bf16 v28, v70, v34, v28
    v_dot2_f32_bf16 v29, v70, v70, v29
    v_dot2_f32_bf16 v32, v71, v34, v32
    v_dot2_f32_bf16 v33, v71, v71, v33
    s_waitcnt lgkmcnt(9)
    v_dot2_f32_bf16 v28, v72, v34, v28
    v_dot2_f32_bf16 v29, v72, v72, v29
    v_dot2_f32_bf16 v32, v73, v34, v32
    v_dot2_f32_bf16 v33, v73, v73, v33
    s_waitcnt lgkmcnt(8)
    v_dot2_f32_bf16 v28, v74, v34, v28
    v_dot2_f32_bf16 v29, v74, v74, v29
    v_dot2_f32_bf16 v32, v75, v34, v32
    v_dot2_f32_bf16 v33, v75, v75, v33
    s_waitcnt lgkmcnt(7)
    v_dot2_f32_bf16 v28, v76, v34, v28
    v_dot2_f32_bf16 v29, v76, v76, v29
    v_dot2_f32_bf16 v32, v77, v34, v32
    v_dot2_f32_bf16 v33, v77, v77, v33
    s_waitcnt lgkmcnt(6)
    v_dot2_f32_bf16 v28, v78, v34, v28
    v_dot2_f32_bf16 v29, v78, v78, v29
    v_dot2_f32_bf16 v32, v79, v34, v32
    v_dot2_f32_bf16 v33, v79, v79, v33
    s_waitcnt lgkmcnt(5)
    v_dot2_f32_bf16 v28, v80, v34, v28
    v_dot2_f32_bf16 v29, v80, v80, v29
    v_dot2_f32_bf16 v32, v81, v34, v32
    v_dot2_f32_bf16 v33, v81, v81, v33
    s_waitcnt lgkmcnt(4)
    v_dot2_f32_bf16 v28, v82, v34, v28
    v_dot2_f32_bf16 v29, v82, v82, v29
    v_dot2_f32_bf16 v32, v83, v34, v32
    v_dot2_f32_bf16 v33, v83, v83, v33
    s_waitcnt lgkmcnt(3)
    v_dot2_f32_bf16 v28, v84, v34, v28
    v_dot2_f32_bf16 v29, v84, v84, v29
    v_dot2_f32_bf16 v32, v85, v34, v32
    v_dot2_f32_bf16 v33, v85, v85, v33
    s_waitcnt lgkmcnt(2)
    v_dot2_f32_bf16 v28, v86, v34, v28
    v_dot2_f32_bf16 v29, v86, v86, v29
    v_dot2_f32_bf16 v32, v87, v34, v32
    v_dot2_f32_bf16 v33, v87, v87, v33
    s_waitcnt lgkmcnt(1)
    v_dot2_f32_bf16 v28, v88, v34, v28
    v_dot2_f32_bf16 v29, v88, v88, v29
    v_dot2_f32_bf16 v32, v89, v34, v32
    v_dot2_f32_bf16 v33, v89, v89, v33
    s_waitcnt lgkmcnt(0)
    v_dot2_f32_bf16 v28, v90, v34, v28
    v_dot2_f32_bf16 v29, v90, v90, v29
    v_dot2_f32_bf16 v32, v91, v34, v32
    v_dot2_f32_bf16 v33, v91, v91, v33
    s_nop 1
    v_add_f32 v28, v28, v32
    v_add_f32 v29, v29, v33
    v_mov_b32 v35, v28
    s_nop 1
    v_permlane32_swap_b32 v35, v28
    v_add_f32 v28, v28, v35
    v_mov_b32 v35, v29
    s_nop 1
    v_permlane32_swap_b32 v35, v29
    v_add_f32 v29, v29, v35
    ds_write_b64 v22, v[28:29]
    s_waitcnt lgkmcnt(0)
    s_barrier
    ds_read_b64 v[92:93], v23
    ds_read_b64 v[94:95], v23 offset:256
    s_waitcnt lgkmcnt(0)
    v_add_f32 v28, v92, v94
    v_add_f32 v29, v93, v95
    v_mul_f32 v28, 0x3b124925, v28
    v_mul_f32 v29, 0x3b124925, v29
    v_fma_f32 v29, -v28, v28, v29
    v_max_f32 v29, 0, v29
    v_add_f32 v29, 0x3727c5ac, v29
    v_rsq_f32 v35, v29
    s_nop 0
    v_mul_f32 v30, v29, v35
    v_mul_f32 v29, 0xbfb8aa3b, v35
    v_mov_b32 v31, s93
    buffer_store_dwordx4 v[28:31], v24, s[44:47], 0 offen sc1
    s_waitcnt vmcnt(0)
L_end:
    s_endpgm
.section .rodata,"a"
.p2align 6
.amdhsa_kernel sequential_preLN__ssm_conv_h3__glu_gated_glu__prompt_kernel
  .amdhsa_next_free_vgpr 512
  .amdhsa_next_free_sgpr 102
  .amdhsa_accum_offset 256
  .amdhsa_group_segment_fixed_size 0
  .amdhsa_kernarg_size 104
  .amdhsa_user_sgpr_count 2
  .amdhsa_user_sgpr_kernarg_segment_ptr 1
  .amdhsa_system_sgpr_workgroup_id_x 1
  .amdhsa_float_denorm_mode_32 3
.end_amdhsa_kernel
```
